```python
import torch

def _softmax(x, axis=-1):
    return torch.softmax(x, dim=axis)
def _gelu(x):
    return torch.nn.functional.gelu(x, approximate="tanh")
def _silu(x):
    return torch.nn.functional.silu(x)
def _sigmoid(x):
    return torch.sigmoid(x)
def _layernorm(x, axis=-1, eps=1e-5):
    m = x.mean(dim=axis, keepdim=True)
    v = x.var(dim=axis, keepdim=True, unbiased=False)
    return (x - m) / torch.sqrt(v + eps)
def _scatter_add(tgt, idx, src, axis=0):
    return tgt.clone().index_add_(axis, idx, src)
def _segment_sum(src, seg, n):
    out = torch.zeros((n,) + src.shape[1:], dtype=src.dtype)
    return out.index_add_(0, seg, src)
def _pad(x, pw):
    flat = tuple(v for pair in reversed(pw) for v in pair)
    return torch.nn.functional.pad(x, flat)

kernel_name = 'standalone__kernel_systems_refs_featgraph__graph'

def setup_inputs():

    _w = (lambda a: (lambda t: t.to(torch.bfloat16) if t.is_floating_point() else t)(torch.as_tensor(a)))
    N, deg, D = 10000, 16, 256
    E = N * deg
    scale = D ** -0.5
    src = (lambda lo, hi, *s: torch.randint(lo, hi, s))(0, N, E).to(torch.int64)
    dst = (lambda lo, hi, *s: torch.randint(lo, hi, s))(0, N, E).to(torch.int64)
    return {
        "x": _w((lambda *s: torch.randn(*s, dtype=torch.bfloat16) * 0.8)(N, D)),
        "src": _w(src),
        "dst": _w(dst),
        "w_q": _w((lambda *s: torch.randn(*s, dtype=torch.bfloat16) * 0.8)(D, D) * scale),
        "w_v": _w((lambda *s: torch.randn(*s, dtype=torch.bfloat16) * 0.05)(D, D) * scale),
    }

def reference(x, src, dst, w_q, w_v):
    N, D = x.shape
    xs = x[src]
    xd = x[dst]
    q = xd @ w_q
    logits = torch.einsum('ed,ed->e', xs, q) * (float(D) ** -0.5)
    alpha = _sigmoid(logits)
    msg = alpha[:, None] * (xs @ w_v)
    return _segment_sum(msg, dst, N)
```

```asm
; @launch grid=(256,1,1) block=(768,1,1) lds=95488
.amdgcn_target "amdgcn-amd-amdhsa--gfx950"
.text
.globl standalone__kernel_systems_refs_featgraph__graph_kernel
.p2align 8
.type standalone__kernel_systems_refs_featgraph__graph_kernel,@function
standalone__kernel_systems_refs_featgraph__graph_kernel:
    s_load_dwordx8 s[12:19], s[0:1], 8
    s_load_dwordx2 s[8:9], s[0:1], 0
    v_readfirstlane_b32 s3, v0
    s_cmpk_ge_u32 s2, 256
    s_cbranch_scc1 L_end
    s_cmpk_ge_u32 s3, 512
    s_cbranch_scc1 L_matrix
    s_load_dwordx2 s[20:21], s[0:1], 56
    v_bfrev_b32 v4, -2
    v_bfrev_b32 v5, -2
    v_lshlrev_b32 v94, 4, v0
    v_mov_b64 v[6:7], v[4:5]
    ds_write_b128 v94, v[4:7] offset:36864
    s_and_b32 s28, s2, 63
    s_mul_i32 s29, s28, 10000
    v_min_u32 v2, 451, v0
    v_add_u32 v3, s29, v94
    s_addk_i32 s29, 0x2000
    v_lshl_add_u32 v2, v2, 2, s29
    s_lshr_b32 s30, s2, 6
    s_lshl_b32 s6, s30, 8
    s_setprio 3
    s_waitcnt lgkmcnt(0)
    global_load_dwordx4 v[40:43], v3, s[14:15]
    s_load_dword s31, s[20:21], s6
    global_load_dword v44, v2, s[14:15]
    global_load_dwordx4 v[48:51], v3, s[12:13]
    global_load_dword v52, v2, s[12:13]
    ds_write_b128 v94, v[4:7] offset:20480
    ds_write_b128 v94, v[4:7] offset:28672
    s_lshr_b32 s3, s3, 6
    s_barrier
    s_branch L_g2
L_matrix:
    s_load_dwordx2 s[24:25], s[0:1], 40
    s_setprio 2
    v_subrev_u32 v1, 512, v0
    s_lshr_b32 s3, s3, 6
    s_sub_u32 s30, s3, 8
    s_getpc_b64 s[42:43]
L_pc:
    s_bfe_u32 s6, s2, 0x20003
    s_lshl2_add_u32 s6, s6, s30
    s_lshl_b32 s6, s6, 7
    v_and_b32 v0, 63, v0
    v_lshl_add_u32 v2, v0, 11, s6
    v_cmp_gt_u32 vcc, L_end-L_pc, v2
    s_and_b64 exec, vcc, vcc
    global_load_dword v15, v2, s[42:43]
    s_mov_b64 exec, -1
    v_lshlrev_b32 v1, 4, v1
    v_cmp_gt_u32 vcc, 1664, v1
    v_mov_b64 v[8:9], 0
    v_mov_b64 v[10:11], 0
    v_cndmask_b32 v4, 0, -1, vcc
    v_cndmask_b32 v5, 0, -1, vcc
    v_mov_b64 v[6:7], v[4:5]
    ds_write_b128 v1, v[4:7] offset:45056
    ds_write_b128 v1, v[8:11] offset:49152
    s_mul_i32 s6, s2, 625
    s_add_u32 s4, s6, 15
    s_add_u32 s5, s6, 640
    s_lshr_b32 s4, s4, 4
    s_lshr_b32 s5, s5, 4
    s_sub_u32 s5, s5, s4
    s_mov_b32 s62, 0
    s_mov_b32 s10, 5120000
    s_mov_b32 s11, 0x20000
    s_lshl_b32 s6, s30, 1
    v_lshrrev_b32 v1, 5, v0
    v_or_b32 v1, s6, v1
    v_and_b32 v2, 31, v0
    v_xor_b32 v2, v1, v2
    v_lshlrev_b32 v2, 4, v2
    v_lshl_or_b32 v16, v1, 9, v2
    v_xor_b32 v17, 0x80, v16
    s_lshl_b32 s31, s4, 9
    s_lshl_b32 s33, s30, 10
    s_add_u32 m0, s33, 53248
    s_lshr_b32 s6, s2, 3
    s_lshl_b32 s6, s6, 12
    s_add_u32 s6, s6, s33
    v_lshl_add_u32 v18, v0, 7, s6
    s_mov_b32 s34, s31
    s_lshl2_add_u32 s6, s2, s30
    s_lshl_b32 s6, s6, 7
    v_mov_b32 v24, s6
    v_lshlrev_b32 v23, 21, v0
    s_mov_b64 exec, 0xff
    s_waitcnt lgkmcnt(0)
    s_barrier
    global_load_dword v15, v18, s[16:17]
    s_mov_b64 exec, 1
    global_load_dword v15, v24, s[18:19]
    s_mov_b64 exec, -1
    buffer_load_dwordx4 v16, s[8:11], s34 offen lds
    s_add_u32 m0, m0, 4096
    s_addk_i32 s34, 0x1000
    buffer_load_dwordx4 v17, s[8:11], s34 offen lds
    s_add_u32 m0, m0, 4096
    s_addk_i32 s34, 0x1000
    buffer_load_dwordx4 v16, s[8:11], s34 offen lds
    s_add_u32 m0, m0, 4096
    s_addk_i32 s34, 0x1000
    buffer_load_dwordx4 v17, s[8:11], s34 offen lds
    s_add_u32 m0, m0, 4096
    s_addk_i32 s34, 0x1000
    buffer_load_dwordx4 v16, s[8:11], s34 offen lds
    s_mov_b64 exec, 7
    buffer_load_dword v15, v23, s[8:11], s33 offen
    s_mov_b64 exec, -1
    s_barrier
    s_branch L_m2
L_g2:
    v_mov_b32 v85, 0x68db9
    s_lshl_b32 s6, s30, 30
    s_sub_u32 s6, 0, s6
    v_mov_b32 v86, s6
    v_mov_b32 v87, 31
    v_mov_b32 v93, 0
    s_mov_b32 s62, 0
    v_mov_b32 v89, 0x3fffff
    v_cmp_gt_u32 vcc, 452, v0
    v_lshrrev_b32 v3, 3, v0
    v_and_b32 v8, 7, v0
    v_mul_u32_u24 v9, 272, v8
    v_lshl_add_u32 v88, v3, 2, v9
    v_mul_u32_u24 v9, 8320, v3
    v_lshl_or_b32 v84, v8, 4, v9
    s_mov_b64 s[54:55], vcc
    s_mov_b32 s22, 2134016
    s_mov_b32 s23, 0x20000
    s_mul_i32 s56, s30, 532480
    s_lshl_b32 s6, s28, 7
    s_add_u32 s56, s56, s6
    s_addk_i32 s56, 4096
    s_mov_b32 s6, 0x40000000
    s_movk_i32 s7, 272
    s_waitcnt vmcnt(2)
    v_mad_u32_u24 v56, v40, v85, v86
    v_cmpx_gt_u32 s[44:45], s6, v56
    v_lshlrev_b32_sdwa v64, 2, v56 dst_sel:DWORD dst_unused:UNUSED_PAD src0_sel:DWORD src1_sel:BYTE_3
    ds_inc_rtn_u32 v72, v64, v87 offset:46720
    s_mov_b64 exec, -1
    v_mad_u32_u24 v57, v41, v85, v86
    v_cmpx_gt_u32 s[46:47], s6, v57
    v_lshlrev_b32_sdwa v65, 2, v57 dst_sel:DWORD dst_unused:UNUSED_PAD src0_sel:DWORD src1_sel:BYTE_3
    ds_inc_rtn_u32 v73, v65, v87 offset:46720
    s_mov_b64 exec, -1
    v_mad_u32_u24 v58, v42, v85, v86
    v_cmpx_gt_u32 s[48:49], s6, v58
    v_lshlrev_b32_sdwa v66, 2, v58 dst_sel:DWORD dst_unused:UNUSED_PAD src0_sel:DWORD src1_sel:BYTE_3
    ds_inc_rtn_u32 v74, v66, v87 offset:46720
    s_mov_b64 exec, -1
    v_mad_u32_u24 v59, v43, v85, v86
    v_cmpx_gt_u32 s[50:51], s6, v59
    v_lshlrev_b32_sdwa v67, 2, v59 dst_sel:DWORD dst_unused:UNUSED_PAD src0_sel:DWORD src1_sel:BYTE_3
    ds_inc_rtn_u32 v75, v67, v87 offset:46720
    s_mov_b64 exec, s[54:55]
    v_mad_u32_u24 v60, v44, v85, v86
    v_cmpx_gt_u32 s[52:53], s6, v60
    v_lshlrev_b32_sdwa v68, 2, v60 dst_sel:DWORD dst_unused:UNUSED_PAD src0_sel:DWORD src1_sel:BYTE_3
    ds_inc_rtn_u32 v76, v68, v87 offset:46720
    s_mov_b64 exec, s[44:45]
    s_waitcnt vmcnt(1) lgkmcnt(4)
    v_lshl_or_b32 v40, v40, 16, v48
    v_mad_u32_u24 v64, v72, s7, v64
    ds_write_b32 v64, v40 offset:37888
    s_mov_b64 exec, s[46:47]
    s_waitcnt lgkmcnt(4)
    v_lshl_or_b32 v41, v41, 16, v49
    v_mad_u32_u24 v65, v73, s7, v65
    ds_write_b32 v65, v41 offset:37888
    s_mov_b64 exec, s[48:49]
    s_waitcnt lgkmcnt(4)
    v_lshl_or_b32 v42, v42, 16, v50
    v_mad_u32_u24 v66, v74, s7, v66
    ds_write_b32 v66, v42 offset:37888
    s_mov_b64 exec, s[50:51]
    s_waitcnt lgkmcnt(4)
    v_lshl_or_b32 v43, v43, 16, v51
    v_mad_u32_u24 v67, v75, s7, v67
    ds_write_b32 v67, v43 offset:37888
    s_mov_b64 exec, s[52:53]
    s_waitcnt vmcnt(0) lgkmcnt(4)
    v_lshl_or_b32 v44, v44, 16, v52
    v_mad_u32_u24 v68, v76, s7, v68
    ds_write_b32 v68, v44 offset:37888
    s_mov_b64 exec, -1
    s_waitcnt lgkmcnt(0)
    s_barrier
    ds_read_b32 v80, v88 offset:37888
    ds_read_b32 v81, v88 offset:40064
    ds_read_b32 v82, v88 offset:42240
    ds_read_b32 v83, v88 offset:44416
    s_add_u32 s31, s31, 0x400000
    s_and_b32 s40, s31, 0xffc00000
    s_add_u32 s41, s40, 0x5a400000
    s_add_u32 s42, s41, 0x5a400000
    s_add_u32 s43, s42, 0x5a400000
    s_waitcnt lgkmcnt(0)
    v_and_or_b32 v80, v80, v89, s40
    v_and_or_b32 v81, v81, v89, s41
    v_and_or_b32 v82, v82, v89, s42
    v_and_or_b32 v83, v83, v89, s43
    buffer_store_dwordx4 v[80:83], v84, s[20:23], s56 offen sc1
    s_mul_i32 s6, s2, 625
    s_add_u32 s4, s6, 15
    s_add_u32 s5, s6, 640
    s_lshr_b32 s4, s4, 4
    s_lshr_b32 s5, s5, 4
    s_sub_u32 s5, s5, s4
    s_mov_b32 s62, 0
    s_mov_b32 s10, 5120000
    s_mov_b32 s11, 0x20000
    v_mov_b32 v90, 65
    v_mov_b32 v91, 0xfc
    v_mov_b32 v92, 1
    v_mov_b32 v93, 0
    v_and_b32 v8, 15, v0
    v_bfe_u32 v9, v0, 4, 2
    v_lshlrev_b32 v1, 4, v8
    v_lshlrev_b32 v2, 6, v9
    v_lshrrev_b32 v10, 1, v9
    v_and_b32 v11, 1, v9
    v_lshl_or_b32 v12, v10, 8, v1
    v_lshl_or_b32 v12, v11, 3, v12
    v_add_u32 v4, 73728, v12
    s_lshl_b32 s6, s3, 9
    s_add_u32 s6, s6, 49152
    v_lshrrev_b32 v12, 1, v8
    v_lshl_add_u32 v12, v12, 6, s6
    v_lshl_add_u32 v12, v10, 5, v12
    v_lshl_add_u32 v12, v11, 3, v12
    v_and_b32 v13, 1, v0
    v_mad_u32_u24 v6, v13, 20, v12
    v_lshl_add_u32 v12, v11, 5, s6
    v_bfe_u32 v13, v0, 2, 1
    v_lshl_add_u32 v12, v13, 4, v12
    v_lshrrev_b32 v13, 3, v8
    v_cmp_eq_u32 vcc, v13, v10
    v_mov_b32 v14, 47488
    v_and_b32 v13, 3, v0
    v_cndmask_b32 v7, v14, v12, vcc
    v_xor_b32 v10, 2, v13
    v_lshl_or_b32 v13, v10, 2, v13
    v_mul_u32_u24 v3, 0x1111, v13
    v_mov_b64 v[16:17], 0
    v_mov_b64 v[18:19], 0
    v_and_b32 v5, 63, v0
    v_lshlrev_b32 v5, 2, v5
    s_mul_i32 s57, s2, 8320
    s_addk_i32 s57, 4096
    s_mov_b32 s58, 0
    s_mov_b32 s32, s3
    s_add_u32 s33, s3, 8
    s_mov_b32 s36, 0
    s_mov_b32 s37, 0
    s_add_u32 s39, s3, s4
    s_and_b32 s39, s39, 63
    s_mul_i32 s7, s39, 272
    v_add_u32 v95, s7, v2
    s_mov_b32 s54, 0xcccccccc
    s_mov_b32 s55, 0xcccccccc
    s_waitcnt vmcnt(0)
L_g_poll:
    buffer_load_dwordx4 v[40:43], v94, s[20:23], s57 offen sc1
    s_add_u32 s58, s58, 0x4000
    s_cbranch_scc1 L_g_timeout
    s_waitcnt vmcnt(0)
    v_xor_b32 v40, s40, v40
    v_xor_b32 v41, s41, v41
    v_xor_b32 v42, s42, v42
    v_xor_b32 v43, s43, v43
    v_or_b32 v48, v40, v41
    v_or3_b32 v48, v48, v42, v43
    v_cmp_lt_u32 vcc, v89, v48
    s_and_b64 exec, vcc, vcc
    s_cbranch_scc1 L_g_poll
    s_mov_b64 exec, -1
    v_cmpx_ne_u16 s[44:45], -1, v40
    v_lshlrev_b32_sdwa v64, 2, v40 dst_sel:DWORD dst_unused:UNUSED_PAD src0_sel:DWORD src1_sel:WORD_1
    ds_add_rtn_u32 v72, v64, v90 offset:46976
    v_cmpx_ne_u16 s[46:47], -1, v41
    v_lshlrev_b32_sdwa v65, 2, v41 dst_sel:DWORD dst_unused:UNUSED_PAD src0_sel:DWORD src1_sel:WORD_1
    ds_add_rtn_u32 v73, v65, v90 offset:46976
    v_cmpx_ne_u16 s[48:49], -1, v42
    v_lshlrev_b32_sdwa v66, 2, v42 dst_sel:DWORD dst_unused:UNUSED_PAD src0_sel:DWORD src1_sel:WORD_1
    ds_add_rtn_u32 v74, v66, v90 offset:46976
    s_mov_b64 exec, -1
    v_cmp_ne_u16 vcc, -1, v43
    v_mul_u32_u24 v64, 68, v64
    v_lshlrev_b32_sdwa v40, 9, v40 dst_sel:DWORD dst_unused:UNUSED_PAD src0_sel:DWORD src1_sel:WORD_0
    v_mul_u32_u24 v65, 68, v65
    v_lshlrev_b32_sdwa v41, 9, v41 dst_sel:DWORD dst_unused:UNUSED_PAD src0_sel:DWORD src1_sel:WORD_0
    v_mul_u32_u24 v66, 68, v66
    v_lshlrev_b32_sdwa v42, 9, v42 dst_sel:DWORD dst_unused:UNUSED_PAD src0_sel:DWORD src1_sel:WORD_0
    s_cmp_lg_u64 vcc, 0
    s_cbranch_scc1 L_g_c3
L_g_c012:
    s_mov_b64 exec, s[44:45]
    s_waitcnt lgkmcnt(2)
    v_and_b32 v72, v91, v72
    v_add_u32 v64, v64, v72
    ds_write_b32 v64, v40 offset:20480
    s_mov_b64 exec, s[46:47]
    s_waitcnt lgkmcnt(2)
    v_and_b32 v73, v91, v73
    v_add_u32 v65, v65, v73
    ds_write_b32 v65, v41 offset:20480
    s_mov_b64 exec, s[48:49]
    s_waitcnt lgkmcnt(2)
    v_and_b32 v74, v91, v74
    v_add_u32 v66, v66, v74
    ds_write_b32 v66, v42 offset:20480
L_g_cdone:
    s_mov_b64 exec, 1
    ds_add_u32 v93, v92 offset:47240
    s_mov_b64 exec, -1
L_g_csync:
    ds_read_b64 v[104:105], v93 offset:47240
    s_add_u32 s62, s62, 128
    s_cbranch_scc1 L_end
    s_waitcnt lgkmcnt(0)
    v_readfirstlane_b32 s6, v104
    s_cmp_lg_u32 s6, 8
    s_cbranch_scc1 L_g_csync
    ds_read_b32 v106, v5 offset:46976
    ds_read_b128 v[100:103], v95 offset:20480
    ds_read_b128 v[96:99], v95 offset:20496
    v_readfirstlane_b32 s47, v105
    s_cmp_lt_u32 s3, 2
    s_cbranch_scc1 L_g_hi
    s_setprio 1
L_g_hi:
    s_cmp_lg_u32 s47, 0
    s_waitcnt lgkmcnt(2)
    v_add_u32 v5, 192, v106
    v_lshrrev_b32 v5, 8, v5
    s_cbranch_scc1 L_g_allslow
L_g_first:
    v_readlane_b32 s34, v5, s39
    s_waitcnt lgkmcnt(0)
    s_cmp_eq_u32 s34, 4
    s_cbranch_scc1 L_issF_4
    s_cmp_eq_u32 s34, 5
    s_cbranch_scc1 L_issF_3
    s_cmp_eq_u32 s34, 3
    s_cbranch_scc1 L_issF_5
    s_cmp_eq_u32 s34, 6
    s_cbranch_scc1 L_issF_2
    s_cmp_eq_u32 s34, 7
    s_cbranch_scc1 L_issF_1
    s_cmp_eq_u32 s34, 2
    s_cbranch_scc1 L_issF_6
    s_cmp_eq_u32 s34, 1
    s_cbranch_scc1 L_issF_7
    s_cmp_eq_u32 s34, 0
    s_cbranch_scc1 L_issuedF
    s_cmp_lg_u32 s34, 8
    s_cbranch_scc1 L_fixF
L_issF_0:
    v_or_b32 v99, v99, v1
    buffer_load_dwordx4 v[40:43], v99, s[8:11], 0 offen
    buffer_load_dwordx4 v[44:47], v99, s[8:11], 0 offen offset:256
L_issF_1:
    v_or_b32 v98, v98, v1
    buffer_load_dwordx4 v[48:51], v98, s[8:11], 0 offen
    buffer_load_dwordx4 v[52:55], v98, s[8:11], 0 offen offset:256
L_issF_2:
    v_or_b32 v97, v97, v1
    buffer_load_dwordx4 v[56:59], v97, s[8:11], 0 offen
    buffer_load_dwordx4 v[60:63], v97, s[8:11], 0 offen offset:256
L_issF_3:
    v_or_b32 v96, v96, v1
    buffer_load_dwordx4 v[64:67], v96, s[8:11], 0 offen
    buffer_load_dwordx4 v[68:71], v96, s[8:11], 0 offen offset:256
L_issF_4:
    v_or_b32 v103, v103, v1
    buffer_load_dwordx4 v[72:75], v103, s[8:11], 0 offen
    buffer_load_dwordx4 v[76:79], v103, s[8:11], 0 offen offset:256
L_issF_5:
    v_or_b32 v102, v102, v1
    buffer_load_dwordx4 v[80:83], v102, s[8:11], 0 offen
    buffer_load_dwordx4 v[84:87], v102, s[8:11], 0 offen offset:256
L_issF_6:
    v_or_b32 v101, v101, v1
    buffer_load_dwordx4 v[88:91], v101, s[8:11], 0 offen
    buffer_load_dwordx4 v[92:95], v101, s[8:11], 0 offen offset:256
L_issF_7:
    v_or_b32 v100, v100, v1
    buffer_load_dwordx4 v[96:99], v100, s[8:11], 0 offen
    buffer_load_dwordx4 v[100:103], v100, s[8:11], 0 offen offset:256
L_issuedF:
    s_setprio 1
    s_add_u32 s39, s33, s4
    s_and_b32 s39, s39, 63
    s_mul_i32 s6, s39, 272
    v_add_u32 v36, s6, v2
    ds_read_b128 v[164:167], v36 offset:20480
    ds_read_b128 v[160:163], v36 offset:20496
    v_readlane_b32 s35, v5, s39
    s_mov_b64 exec, 1
L_g_qwait:
    ds_read_b32 v20, v1 offset:47248
    s_add_u32 s62, s62, 128
    s_cbranch_scc1 L_end
    s_waitcnt lgkmcnt(0)
    v_readfirstlane_b32 s6, v20
    s_cmp_lg_u32 s6, 4
    s_cbranch_scc1 L_g_qwait
    s_mov_b64 exec, -1
    v_lshl_add_u32 v36, s32, 9, v1
    ds_read_b128 v[8:11], v36 offset:0
    ds_read_b128 v[12:15], v36 offset:256
    s_branch L_phA
L_dualA:
    s_cmp_eq_u32 s34, 5
    s_cbranch_scc1 L_redA_5
    s_cmp_eq_u32 s34, 6
    s_cbranch_scc1 L_redA_6
    v_add_f32_dpp v20, v20, v20 row_ror:8 row_mask:0xf bank_mask:0xf
    v_add_f32_dpp v20, v21, v21 row_ror:8 row_mask:0xf bank_mask:0xc
    s_nop 1
    v_add_f32_dpp v21, v20, v20 row_half_mirror row_mask:0xf bank_mask:0xf
L_redA_6:
    v_add_f32_dpp v22, v22, v22 row_ror:8 row_mask:0xf bank_mask:0xf
L_redA_5:
    v_add_f32_dpp v22, v23, v23 row_ror:8 row_mask:0xf bank_mask:0xc
    v_add_f32_dpp v24, v24, v24 row_ror:8 row_mask:0xf bank_mask:0xf
    v_add_f32_dpp v26, v26, v26 row_ror:8 row_mask:0xf bank_mask:0xf
    v_add_f32_dpp v24, v25, v25 row_ror:8 row_mask:0xf bank_mask:0xc
    v_add_f32_dpp v26, v27, v27 row_ror:8 row_mask:0xf bank_mask:0xc
    v_add_f32_dpp v21, v22, v22 row_half_mirror row_mask:0xf bank_mask:0xa
    v_add_f32_dpp v25, v24, v24 row_half_mirror row_mask:0xf bank_mask:0xf
    v_add_f32_dpp v25, v26, v26 row_half_mirror row_mask:0xf bank_mask:0xa
    v_add_f32_dpp v21, v21, v21 quad_perm:[2,3,0,1] row_mask:0xf bank_mask:0xf
    s_waitcnt lgkmcnt(2)
    v_add_f32_dpp v25, v25, v25 quad_perm:[2,3,0,1] row_mask:0xf bank_mask:0xf
    v_cndmask_b32 v25, v21, v25, s[54:55]
    v_readfirstlane_b32 s38, v37
    s_mov_b32 s44, s32
    v_add_f32_dpp v25, v25, v25 quad_perm:[1,0,3,2] row_mask:0xf bank_mask:0xf
    v_mul_f32 v25, 0xbdb8aa3b, v25
    v_exp_f32 v25, v25
    s_add_u32 s32, s38, 16
    v_add_f32 v25, 1.0, v25
    v_rcp_f32 v25, v25
    s_add_u32 s39, s32, s4
    v_cvt_pk_bf16_f32 v0, v25, 0
    ds_write_b32 v6, v0
    ds_read_b128 v[20:23], v7 offset:448
    ds_read_b128 v[24:27], v7 offset:192
    ds_read_b128 v[28:31], v7 offset:320
    ds_read_b128 v[32:35], v7 offset:64
    ds_read_b128 v[36:39], v7 offset:384
    s_and_b32 s39, s39, 63
    s_mul_i32 s45, s39, 272
    s_mul_i32 s46, s38, 544
    s_lshl_b32 s38, s38, 1
    s_cmp_gt_u32 s34, 5
    s_cbranch_scc1 L_longA
    s_waitcnt lgkmcnt(4)
    v_smfmac_f32_16x16x64_bf16 v[16:19], v[20:23], v[96:103], v3
    s_waitcnt lgkmcnt(3)
    v_smfmac_f32_16x16x64_bf16 v[16:19], v[24:27], v[88:95], v3
    s_waitcnt lgkmcnt(2)
    v_smfmac_f32_16x16x64_bf16 v[16:19], v[28:31], v[80:87], v3
    s_waitcnt lgkmcnt(1)
    v_smfmac_f32_16x16x64_bf16 v[16:19], v[32:35], v[72:79], v3
    s_waitcnt lgkmcnt(0)
    v_smfmac_f32_16x16x64_bf16 v[16:19], v[36:39], v[64:71], v3
    s_branch L_pvdoneA
L_longA:
    s_waitcnt lgkmcnt(4)
    v_smfmac_f32_16x16x64_bf16 v[16:19], v[20:23], v[96:103], v3
    ds_read_b128 v[20:23], v7 offset:128
    s_waitcnt lgkmcnt(4)
    v_smfmac_f32_16x16x64_bf16 v[16:19], v[24:27], v[88:95], v3
    ds_read_b128 v[24:27], v7 offset:256
    s_waitcnt lgkmcnt(4)
    v_smfmac_f32_16x16x64_bf16 v[16:19], v[28:31], v[80:87], v3
    ds_read_b128 v[28:31], v7 offset:0
    s_waitcnt lgkmcnt(4)
    v_smfmac_f32_16x16x64_bf16 v[16:19], v[32:35], v[72:79], v3
    s_waitcnt lgkmcnt(3)
    v_smfmac_f32_16x16x64_bf16 v[16:19], v[36:39], v[64:71], v3
    s_waitcnt lgkmcnt(2)
    v_smfmac_f32_16x16x64_bf16 v[16:19], v[20:23], v[56:63], v3
    s_cmp_eq_u32 s34, 6
    s_cbranch_scc1 L_pvdoneA
    s_waitcnt lgkmcnt(1)
    v_smfmac_f32_16x16x64_bf16 v[16:19], v[24:27], v[48:55], v3
    s_cmp_eq_u32 s34, 7
    s_cbranch_scc1 L_pvdoneA
    s_waitcnt lgkmcnt(0)
    v_smfmac_f32_16x16x64_bf16 v[16:19], v[28:31], v[40:47], v3
    s_branch L_pvdoneA
L_fewA:
    s_cmp_eq_u32 s34, 0
    s_cbranch_scc1 L_pvdoneA
    s_cmp_eq_u32 s34, 1
    s_waitcnt lgkmcnt(0)
    v_smfmac_f32_16x16x64_bf16 v[16:19], v[20:23], v[96:103], v3
    s_cbranch_scc1 L_pvdoneA
    v_smfmac_f32_16x16x64_bf16 v[16:19], v[24:27], v[88:95], v3
    s_branch L_pvdoneA
L_phA:
    s_cmp_lg_u32 s36, 0
    s_waitcnt lgkmcnt(0)
    s_cbranch_scc1 L_extraA
L_phA_go:
    s_setprio 3
    s_cmp_eq_u32 s34, 4
    s_cbranch_scc1 L_dotA_4
    s_cmp_eq_u32 s34, 5
    s_cbranch_scc1 L_dotA_3
    s_cmp_eq_u32 s34, 3
    s_cbranch_scc1 L_dotA_5
    s_cmp_eq_u32 s34, 6
    s_cbranch_scc1 L_dotA_2
    s_cmp_eq_u32 s34, 7
    s_cbranch_scc1 L_dotA_1
    s_cmp_eq_u32 s34, 2
    s_cbranch_scc1 L_dotA_6
    s_cmp_eq_u32 s34, 1
    s_cbranch_scc1 L_dotA_7
    s_cmp_eq_u32 s34, 0
    s_cbranch_scc1 L_dotdoneA
L_dotA_0:
    s_waitcnt vmcnt(14)
    v_dot2_f32_bf16 v20, v40, v8, 0
    v_dot2_f32_bf16 v20, v41, v9, v20
    v_dot2_f32_bf16 v20, v42, v10, v20
    v_dot2_f32_bf16 v20, v43, v11, v20
    v_dot2_f32_bf16 v20, v44, v12, v20
    v_dot2_f32_bf16 v20, v45, v13, v20
    v_dot2_f32_bf16 v20, v46, v14, v20
    v_dot2_f32_bf16 v20, v47, v15, v20
L_dotA_1:
    s_waitcnt vmcnt(12)
    v_dot2_f32_bf16 v21, v48, v8, 0
    v_dot2_f32_bf16 v21, v49, v9, v21
    v_dot2_f32_bf16 v21, v50, v10, v21
    v_dot2_f32_bf16 v21, v51, v11, v21
    v_dot2_f32_bf16 v21, v52, v12, v21
    v_dot2_f32_bf16 v21, v53, v13, v21
    v_dot2_f32_bf16 v21, v54, v14, v21
    v_dot2_f32_bf16 v21, v55, v15, v21
L_dotA_2:
    s_waitcnt vmcnt(10)
    v_dot2_f32_bf16 v22, v56, v8, 0
    v_dot2_f32_bf16 v22, v57, v9, v22
    v_dot2_f32_bf16 v22, v58, v10, v22
    v_dot2_f32_bf16 v22, v59, v11, v22
    v_dot2_f32_bf16 v22, v60, v12, v22
    v_dot2_f32_bf16 v22, v61, v13, v22
    v_dot2_f32_bf16 v22, v62, v14, v22
    v_dot2_f32_bf16 v22, v63, v15, v22
L_dotA_3:
    s_waitcnt vmcnt(8)
    v_dot2_f32_bf16 v23, v64, v8, 0
    v_dot2_f32_bf16 v23, v65, v9, v23
    v_dot2_f32_bf16 v23, v66, v10, v23
    v_dot2_f32_bf16 v23, v67, v11, v23
    v_dot2_f32_bf16 v23, v68, v12, v23
    v_dot2_f32_bf16 v23, v69, v13, v23
    v_dot2_f32_bf16 v23, v70, v14, v23
    v_dot2_f32_bf16 v23, v71, v15, v23
L_dotA_4:
    s_waitcnt vmcnt(6)
    v_dot2_f32_bf16 v24, v72, v8, 0
    v_dot2_f32_bf16 v24, v73, v9, v24
    v_dot2_f32_bf16 v24, v74, v10, v24
    v_dot2_f32_bf16 v24, v75, v11, v24
    v_dot2_f32_bf16 v24, v76, v12, v24
    v_dot2_f32_bf16 v24, v77, v13, v24
    v_dot2_f32_bf16 v24, v78, v14, v24
    v_dot2_f32_bf16 v24, v79, v15, v24
L_dotA_5:
    s_waitcnt vmcnt(4)
    v_dot2_f32_bf16 v25, v80, v8, 0
    v_dot2_f32_bf16 v25, v81, v9, v25
    v_dot2_f32_bf16 v25, v82, v10, v25
    v_dot2_f32_bf16 v25, v83, v11, v25
    v_dot2_f32_bf16 v25, v84, v12, v25
    v_dot2_f32_bf16 v25, v85, v13, v25
    v_dot2_f32_bf16 v25, v86, v14, v25
    v_dot2_f32_bf16 v25, v87, v15, v25
L_dotA_6:
    s_waitcnt vmcnt(2)
    v_dot2_f32_bf16 v26, v88, v8, 0
    v_dot2_f32_bf16 v26, v89, v9, v26
    v_dot2_f32_bf16 v26, v90, v10, v26
    v_dot2_f32_bf16 v26, v91, v11, v26
    v_dot2_f32_bf16 v26, v92, v12, v26
    v_dot2_f32_bf16 v26, v93, v13, v26
    v_dot2_f32_bf16 v26, v94, v14, v26
    v_dot2_f32_bf16 v26, v95, v15, v26
L_dotA_7:
    s_waitcnt vmcnt(0)
    v_dot2_f32_bf16 v27, v96, v8, 0
    v_dot2_f32_bf16 v27, v97, v9, v27
    v_dot2_f32_bf16 v27, v98, v10, v27
    v_dot2_f32_bf16 v27, v99, v11, v27
    v_dot2_f32_bf16 v27, v100, v12, v27
    v_dot2_f32_bf16 v27, v101, v13, v27
    v_dot2_f32_bf16 v27, v102, v14, v27
    v_dot2_f32_bf16 v27, v103, v15, v27
L_dotdoneA:
    s_mov_b64 exec, 1
    ds_inc_rtn_u32 v37, v1, v3 offset:47232
    s_mov_b64 exec, -1
    v_lshl_add_u32 v36, s33, 9, v1
    ds_read_b128 v[8:11], v36 offset:0
    ds_read_b128 v[12:15], v36 offset:256
    s_cmp_eq_u32 s35, 0
    s_cbranch_scc1 L_issuedA
    s_setprio 1
    s_cmp_eq_u32 s35, 4
    s_cbranch_scc1 L_issA_4
    s_cmp_eq_u32 s35, 5
    s_cbranch_scc1 L_issA_3
    s_cmp_eq_u32 s35, 3
    s_cbranch_scc1 L_issA_5
    s_cmp_eq_u32 s35, 6
    s_cbranch_scc1 L_issA_2
    s_cmp_eq_u32 s35, 7
    s_cbranch_scc1 L_issA_1
    s_cmp_eq_u32 s35, 2
    s_cbranch_scc1 L_issA_6
    s_cmp_eq_u32 s35, 1
    s_cbranch_scc1 L_issA_7
    s_cmp_eq_u32 s35, 0
    s_cbranch_scc1 L_issuedA
    s_cmp_lg_u32 s35, 8
    s_cbranch_scc1 L_fixA
L_issA_0:
    v_or_b32 v163, v163, v1
    buffer_load_dwordx4 v[104:107], v163, s[8:11], 0 offen
    buffer_load_dwordx4 v[108:111], v163, s[8:11], 0 offen offset:256
L_issA_1:
    v_or_b32 v162, v162, v1
    buffer_load_dwordx4 v[112:115], v162, s[8:11], 0 offen
    buffer_load_dwordx4 v[116:119], v162, s[8:11], 0 offen offset:256
L_issA_2:
    v_or_b32 v161, v161, v1
    buffer_load_dwordx4 v[120:123], v161, s[8:11], 0 offen
    buffer_load_dwordx4 v[124:127], v161, s[8:11], 0 offen offset:256
L_issA_3:
    v_or_b32 v160, v160, v1
    buffer_load_dwordx4 v[128:131], v160, s[8:11], 0 offen
    buffer_load_dwordx4 v[132:135], v160, s[8:11], 0 offen offset:256
L_issA_4:
    v_or_b32 v167, v167, v1
    buffer_load_dwordx4 v[136:139], v167, s[8:11], 0 offen
    buffer_load_dwordx4 v[140:143], v167, s[8:11], 0 offen offset:256
L_issA_5:
    v_or_b32 v166, v166, v1
    buffer_load_dwordx4 v[144:147], v166, s[8:11], 0 offen
    buffer_load_dwordx4 v[148:151], v166, s[8:11], 0 offen offset:256
L_issA_6:
    v_or_b32 v165, v165, v1
    buffer_load_dwordx4 v[152:155], v165, s[8:11], 0 offen
    buffer_load_dwordx4 v[156:159], v165, s[8:11], 0 offen offset:256
L_issA_7:
    v_or_b32 v164, v164, v1
    buffer_load_dwordx4 v[160:163], v164, s[8:11], 0 offen
    buffer_load_dwordx4 v[164:167], v164, s[8:11], 0 offen offset:256
L_issuedA:
    s_setprio 3
    s_cmp_gt_u32 s34, 4
    s_cbranch_scc1 L_dualA
    v_add_f32_dpp v24, v24, v24 row_ror:8 row_mask:0xf bank_mask:0xf
    v_add_f32_dpp v26, v26, v26 row_ror:8 row_mask:0xf bank_mask:0xf
    v_add_f32_dpp v24, v25, v25 row_ror:8 row_mask:0xf bank_mask:0xc
    v_add_f32_dpp v26, v27, v27 row_ror:8 row_mask:0xf bank_mask:0xc
    s_waitcnt lgkmcnt(2)
    v_add_f32_dpp v25, v24, v24 row_half_mirror row_mask:0xf bank_mask:0xf
    v_add_f32_dpp v25, v26, v26 row_half_mirror row_mask:0xf bank_mask:0xa
    v_readfirstlane_b32 s38, v37
    s_mov_b32 s44, s32
    v_add_f32_dpp v25, v25, v25 quad_perm:[2,3,0,1] row_mask:0xf bank_mask:0xf
    s_add_u32 s32, s38, 16
    s_add_u32 s39, s32, s4
    v_add_f32_dpp v25, v25, v25 quad_perm:[1,0,3,2] row_mask:0xf bank_mask:0xf
    v_mul_f32 v25, 0xbdb8aa3b, v25
    v_exp_f32 v25, v25
    s_and_b32 s39, s39, 63
    v_add_f32 v25, 1.0, v25
    v_rcp_f32 v25, v25
    s_mul_i32 s45, s39, 272
    v_cvt_pk_bf16_f32 v0, v25, 0
    ds_write_b32 v6, v0
    ds_read_b128 v[20:23], v7 offset:448
    ds_read_b128 v[24:27], v7 offset:192
    ds_read_b128 v[28:31], v7 offset:320
    ds_read_b128 v[32:35], v7 offset:64
    s_mul_i32 s46, s38, 544
    s_lshl_b32 s38, s38, 1
    s_cmp_lt_u32 s34, 3
    s_cbranch_scc1 L_fewA
    s_cmp_eq_u32 s34, 3
    s_waitcnt lgkmcnt(3)
    v_smfmac_f32_16x16x64_bf16 v[16:19], v[20:23], v[96:103], v3
    s_waitcnt lgkmcnt(2)
    v_smfmac_f32_16x16x64_bf16 v[16:19], v[24:27], v[88:95], v3
    s_waitcnt lgkmcnt(1)
    v_smfmac_f32_16x16x64_bf16 v[16:19], v[28:31], v[80:87], v3
    s_cbranch_scc1 L_pvdoneA
    s_waitcnt lgkmcnt(0)
    v_smfmac_f32_16x16x64_bf16 v[16:19], v[32:35], v[72:79], v3
L_pvdoneA:
    v_add_u32 v36, s46, v4
    v_mov_b32 v37, s38
    v_mov_b32 v0, s44
    v_add_u32 v40, s45, v2
    v_readlane_b32 s34, v5, s39
    ds_read_b128 v[100:103], v40 offset:20480
    ds_read_b128 v[96:99], v40 offset:20496
    s_cmp_lt_u32 s33, s5
    v_cvt_pk_bf16_f32 v38, v16, v17
    v_cvt_pk_bf16_f32 v39, v18, v19
    ds_write_b64 v36, v[38:39]
    ds_write_b16 v37, v0 offset:46592
    v_mov_b64 v[16:17], 0
    v_mov_b64 v[18:19], 0
    s_cbranch_scc0 L_g_exit
L_phB:
    s_cmp_lg_u32 s37, 0
    s_waitcnt lgkmcnt(0)
    s_cbranch_scc1 L_extraB
L_phB_go:
    s_cmp_eq_u32 s35, 4
    s_cbranch_scc1 L_dotB_4
    s_cmp_eq_u32 s35, 5
    s_cbranch_scc1 L_dotB_3
    s_cmp_eq_u32 s35, 3
    s_cbranch_scc1 L_dotB_5
    s_cmp_eq_u32 s35, 6
    s_cbranch_scc1 L_dotB_2
    s_cmp_eq_u32 s35, 7
    s_cbranch_scc1 L_dotB_1
    s_cmp_eq_u32 s35, 2
    s_cbranch_scc1 L_dotB_6
    s_cmp_eq_u32 s35, 1
    s_cbranch_scc1 L_dotB_7
    s_cmp_eq_u32 s35, 0
    s_cbranch_scc1 L_dotdoneB
L_dotB_0:
    s_waitcnt vmcnt(14)
    v_dot2_f32_bf16 v20, v104, v8, 0
    v_dot2_f32_bf16 v20, v105, v9, v20
    v_dot2_f32_bf16 v20, v106, v10, v20
    v_dot2_f32_bf16 v20, v107, v11, v20
    v_dot2_f32_bf16 v20, v108, v12, v20
    v_dot2_f32_bf16 v20, v109, v13, v20
    v_dot2_f32_bf16 v20, v110, v14, v20
    v_dot2_f32_bf16 v20, v111, v15, v20
L_dotB_1:
    s_waitcnt vmcnt(12)
    v_dot2_f32_bf16 v21, v112, v8, 0
    v_dot2_f32_bf16 v21, v113, v9, v21
    v_dot2_f32_bf16 v21, v114, v10, v21
    v_dot2_f32_bf16 v21, v115, v11, v21
    v_dot2_f32_bf16 v21, v116, v12, v21
    v_dot2_f32_bf16 v21, v117, v13, v21
    v_dot2_f32_bf16 v21, v118, v14, v21
    v_dot2_f32_bf16 v21, v119, v15, v21
L_dotB_2:
    s_waitcnt vmcnt(10)
    v_dot2_f32_bf16 v22, v120, v8, 0
    v_dot2_f32_bf16 v22, v121, v9, v22
    v_dot2_f32_bf16 v22, v122, v10, v22
    v_dot2_f32_bf16 v22, v123, v11, v22
    v_dot2_f32_bf16 v22, v124, v12, v22
    v_dot2_f32_bf16 v22, v125, v13, v22
    v_dot2_f32_bf16 v22, v126, v14, v22
    v_dot2_f32_bf16 v22, v127, v15, v22
L_dotB_3:
    s_waitcnt vmcnt(8)
    v_dot2_f32_bf16 v23, v128, v8, 0
    v_dot2_f32_bf16 v23, v129, v9, v23
    v_dot2_f32_bf16 v23, v130, v10, v23
    v_dot2_f32_bf16 v23, v131, v11, v23
    v_dot2_f32_bf16 v23, v132, v12, v23
    v_dot2_f32_bf16 v23, v133, v13, v23
    v_dot2_f32_bf16 v23, v134, v14, v23
    v_dot2_f32_bf16 v23, v135, v15, v23
L_dotB_4:
    s_waitcnt vmcnt(6)
    v_dot2_f32_bf16 v24, v136, v8, 0
    v_dot2_f32_bf16 v24, v137, v9, v24
    v_dot2_f32_bf16 v24, v138, v10, v24
    v_dot2_f32_bf16 v24, v139, v11, v24
    v_dot2_f32_bf16 v24, v140, v12, v24
    v_dot2_f32_bf16 v24, v141, v13, v24
    v_dot2_f32_bf16 v24, v142, v14, v24
    v_dot2_f32_bf16 v24, v143, v15, v24
L_dotB_5:
    s_waitcnt vmcnt(4)
    v_dot2_f32_bf16 v25, v144, v8, 0
    v_dot2_f32_bf16 v25, v145, v9, v25
    v_dot2_f32_bf16 v25, v146, v10, v25
    v_dot2_f32_bf16 v25, v147, v11, v25
    v_dot2_f32_bf16 v25, v148, v12, v25
    v_dot2_f32_bf16 v25, v149, v13, v25
    v_dot2_f32_bf16 v25, v150, v14, v25
    v_dot2_f32_bf16 v25, v151, v15, v25
L_dotB_6:
    s_waitcnt vmcnt(2)
    v_dot2_f32_bf16 v26, v152, v8, 0
    v_dot2_f32_bf16 v26, v153, v9, v26
    v_dot2_f32_bf16 v26, v154, v10, v26
    v_dot2_f32_bf16 v26, v155, v11, v26
    v_dot2_f32_bf16 v26, v156, v12, v26
    v_dot2_f32_bf16 v26, v157, v13, v26
    v_dot2_f32_bf16 v26, v158, v14, v26
    v_dot2_f32_bf16 v26, v159, v15, v26
L_dotB_7:
    s_waitcnt vmcnt(0)
    v_dot2_f32_bf16 v27, v160, v8, 0
    v_dot2_f32_bf16 v27, v161, v9, v27
    v_dot2_f32_bf16 v27, v162, v10, v27
    v_dot2_f32_bf16 v27, v163, v11, v27
    v_dot2_f32_bf16 v27, v164, v12, v27
    v_dot2_f32_bf16 v27, v165, v13, v27
    v_dot2_f32_bf16 v27, v166, v14, v27
    v_dot2_f32_bf16 v27, v167, v15, v27
L_dotdoneB:
    s_mov_b64 exec, 1
    ds_inc_rtn_u32 v37, v1, v3 offset:47232
    s_mov_b64 exec, -1
    v_lshl_add_u32 v36, s32, 9, v1
    ds_read_b128 v[8:11], v36 offset:0
    ds_read_b128 v[12:15], v36 offset:256
    s_cmp_eq_u32 s34, 0
    s_cbranch_scc1 L_issuedB
    s_setprio 1
    s_cmp_eq_u32 s34, 4
    s_cbranch_scc1 L_issB_4
    s_cmp_eq_u32 s34, 5
    s_cbranch_scc1 L_issB_3
    s_cmp_eq_u32 s34, 3
    s_cbranch_scc1 L_issB_5
    s_cmp_eq_u32 s34, 6
    s_cbranch_scc1 L_issB_2
    s_cmp_eq_u32 s34, 7
    s_cbranch_scc1 L_issB_1
    s_cmp_eq_u32 s34, 2
    s_cbranch_scc1 L_issB_6
    s_cmp_eq_u32 s34, 1
    s_cbranch_scc1 L_issB_7
    s_cmp_eq_u32 s34, 0
    s_cbranch_scc1 L_issuedB
    s_cmp_lg_u32 s34, 8
    s_cbranch_scc1 L_fixB
L_issB_0:
    v_or_b32 v99, v99, v1
    buffer_load_dwordx4 v[40:43], v99, s[8:11], 0 offen
    buffer_load_dwordx4 v[44:47], v99, s[8:11], 0 offen offset:256
L_issB_1:
    v_or_b32 v98, v98, v1
    buffer_load_dwordx4 v[48:51], v98, s[8:11], 0 offen
    buffer_load_dwordx4 v[52:55], v98, s[8:11], 0 offen offset:256
L_issB_2:
    v_or_b32 v97, v97, v1
    buffer_load_dwordx4 v[56:59], v97, s[8:11], 0 offen
    buffer_load_dwordx4 v[60:63], v97, s[8:11], 0 offen offset:256
L_issB_3:
    v_or_b32 v96, v96, v1
    buffer_load_dwordx4 v[64:67], v96, s[8:11], 0 offen
    buffer_load_dwordx4 v[68:71], v96, s[8:11], 0 offen offset:256
L_issB_4:
    v_or_b32 v103, v103, v1
    buffer_load_dwordx4 v[72:75], v103, s[8:11], 0 offen
    buffer_load_dwordx4 v[76:79], v103, s[8:11], 0 offen offset:256
L_issB_5:
    v_or_b32 v102, v102, v1
    buffer_load_dwordx4 v[80:83], v102, s[8:11], 0 offen
    buffer_load_dwordx4 v[84:87], v102, s[8:11], 0 offen offset:256
L_issB_6:
    v_or_b32 v101, v101, v1
    buffer_load_dwordx4 v[88:91], v101, s[8:11], 0 offen
    buffer_load_dwordx4 v[92:95], v101, s[8:11], 0 offen offset:256
L_issB_7:
    v_or_b32 v100, v100, v1
    buffer_load_dwordx4 v[96:99], v100, s[8:11], 0 offen
    buffer_load_dwordx4 v[100:103], v100, s[8:11], 0 offen offset:256
L_issuedB:
    s_setprio 3
    s_cmp_gt_u32 s35, 4
    s_cbranch_scc1 L_dualB
    v_add_f32_dpp v24, v24, v24 row_ror:8 row_mask:0xf bank_mask:0xf
    v_add_f32_dpp v26, v26, v26 row_ror:8 row_mask:0xf bank_mask:0xf
    v_add_f32_dpp v24, v25, v25 row_ror:8 row_mask:0xf bank_mask:0xc
    v_add_f32_dpp v26, v27, v27 row_ror:8 row_mask:0xf bank_mask:0xc
    s_waitcnt lgkmcnt(2)
    v_add_f32_dpp v25, v24, v24 row_half_mirror row_mask:0xf bank_mask:0xf
    v_add_f32_dpp v25, v26, v26 row_half_mirror row_mask:0xf bank_mask:0xa
    v_readfirstlane_b32 s38, v37
    s_mov_b32 s44, s33
    v_add_f32_dpp v25, v25, v25 quad_perm:[2,3,0,1] row_mask:0xf bank_mask:0xf
    s_add_u32 s33, s38, 16
    s_add_u32 s39, s33, s4
    v_add_f32_dpp v25, v25, v25 quad_perm:[1,0,3,2] row_mask:0xf bank_mask:0xf
    v_mul_f32 v25, 0xbdb8aa3b, v25
    v_exp_f32 v25, v25
    s_and_b32 s39, s39, 63
    v_add_f32 v25, 1.0, v25
    v_rcp_f32 v25, v25
    s_mul_i32 s45, s39, 272
    v_cvt_pk_bf16_f32 v0, v25, 0
    ds_write_b32 v6, v0
    ds_read_b128 v[20:23], v7 offset:448
    ds_read_b128 v[24:27], v7 offset:192
    ds_read_b128 v[28:31], v7 offset:320
    ds_read_b128 v[32:35], v7 offset:64
    s_mul_i32 s46, s38, 544
    s_lshl_b32 s38, s38, 1
    s_cmp_lt_u32 s35, 3
    s_cbranch_scc1 L_fewB
    s_cmp_eq_u32 s35, 3
    s_waitcnt lgkmcnt(3)
    v_smfmac_f32_16x16x64_bf16 v[16:19], v[20:23], v[160:167], v3
    s_waitcnt lgkmcnt(2)
    v_smfmac_f32_16x16x64_bf16 v[16:19], v[24:27], v[152:159], v3
    s_waitcnt lgkmcnt(1)
    v_smfmac_f32_16x16x64_bf16 v[16:19], v[28:31], v[144:151], v3
    s_cbranch_scc1 L_pvdoneB
    s_waitcnt lgkmcnt(0)
    v_smfmac_f32_16x16x64_bf16 v[16:19], v[32:35], v[136:143], v3
L_pvdoneB:
    v_add_u32 v36, s46, v4
    v_mov_b32 v37, s38
    v_mov_b32 v0, s44
    v_add_u32 v104, s45, v2
    v_readlane_b32 s35, v5, s39
    ds_read_b128 v[164:167], v104 offset:20480
    ds_read_b128 v[160:163], v104 offset:20496
    s_cmp_lt_u32 s32, s5
    v_cvt_pk_bf16_f32 v38, v16, v17
    v_cvt_pk_bf16_f32 v39, v18, v19
    ds_write_b64 v36, v[38:39]
    ds_write_b16 v37, v0 offset:46592
    v_mov_b64 v[16:17], 0
    v_mov_b64 v[18:19], 0
    s_cbranch_scc1 L_phA
L_g_exit:
    s_cmp_lg_u32 s3, 0
    s_cbranch_scc1 L_g_noep
    s_lshl_b32 s6, s30, 8
    v_mov_b32 v2, s31
    s_mov_b64 exec, 1
    s_cmp_gt_u32 s47, 1
    s_cbranch_scc1 L_g_epmax
    s_cmp_lg_u32 s28, 0
    s_cbranch_scc1 L_g_noep
    buffer_store_dword v2, v1, s[20:23], s6 offen sc0 sc1
L_g_noep:
    s_endpgm
L_dualB:
    s_cmp_eq_u32 s35, 5
    s_cbranch_scc1 L_redB_5
    s_cmp_eq_u32 s35, 6
    s_cbranch_scc1 L_redB_6
    v_add_f32_dpp v20, v20, v20 row_ror:8 row_mask:0xf bank_mask:0xf
    v_add_f32_dpp v20, v21, v21 row_ror:8 row_mask:0xf bank_mask:0xc
    s_nop 1
    v_add_f32_dpp v21, v20, v20 row_half_mirror row_mask:0xf bank_mask:0xf
L_redB_6:
    v_add_f32_dpp v22, v22, v22 row_ror:8 row_mask:0xf bank_mask:0xf
L_redB_5:
    v_add_f32_dpp v22, v23, v23 row_ror:8 row_mask:0xf bank_mask:0xc
    v_add_f32_dpp v24, v24, v24 row_ror:8 row_mask:0xf bank_mask:0xf
    v_add_f32_dpp v26, v26, v26 row_ror:8 row_mask:0xf bank_mask:0xf
    v_add_f32_dpp v24, v25, v25 row_ror:8 row_mask:0xf bank_mask:0xc
    v_add_f32_dpp v26, v27, v27 row_ror:8 row_mask:0xf bank_mask:0xc
    v_add_f32_dpp v21, v22, v22 row_half_mirror row_mask:0xf bank_mask:0xa
    v_add_f32_dpp v25, v24, v24 row_half_mirror row_mask:0xf bank_mask:0xf
    v_add_f32_dpp v25, v26, v26 row_half_mirror row_mask:0xf bank_mask:0xa
    v_add_f32_dpp v21, v21, v21 quad_perm:[2,3,0,1] row_mask:0xf bank_mask:0xf
    s_waitcnt lgkmcnt(2)
    v_add_f32_dpp v25, v25, v25 quad_perm:[2,3,0,1] row_mask:0xf bank_mask:0xf
    v_cndmask_b32 v25, v21, v25, s[54:55]
    v_readfirstlane_b32 s38, v37
    s_mov_b32 s44, s33
    v_add_f32_dpp v25, v25, v25 quad_perm:[1,0,3,2] row_mask:0xf bank_mask:0xf
    v_mul_f32 v25, 0xbdb8aa3b, v25
    v_exp_f32 v25, v25
    s_add_u32 s33, s38, 16
    v_add_f32 v25, 1.0, v25
    v_rcp_f32 v25, v25
    s_add_u32 s39, s33, s4
    v_cvt_pk_bf16_f32 v0, v25, 0
    ds_write_b32 v6, v0
    ds_read_b128 v[20:23], v7 offset:448
    ds_read_b128 v[24:27], v7 offset:192
    ds_read_b128 v[28:31], v7 offset:320
    ds_read_b128 v[32:35], v7 offset:64
    ds_read_b128 v[36:39], v7 offset:384
    s_and_b32 s39, s39, 63
    s_mul_i32 s45, s39, 272
    s_mul_i32 s46, s38, 544
    s_lshl_b32 s38, s38, 1
    s_cmp_gt_u32 s35, 5
    s_cbranch_scc1 L_longB
    s_waitcnt lgkmcnt(4)
    v_smfmac_f32_16x16x64_bf16 v[16:19], v[20:23], v[160:167], v3
    s_waitcnt lgkmcnt(3)
    v_smfmac_f32_16x16x64_bf16 v[16:19], v[24:27], v[152:159], v3
    s_waitcnt lgkmcnt(2)
    v_smfmac_f32_16x16x64_bf16 v[16:19], v[28:31], v[144:151], v3
    s_waitcnt lgkmcnt(1)
    v_smfmac_f32_16x16x64_bf16 v[16:19], v[32:35], v[136:143], v3
    s_waitcnt lgkmcnt(0)
    v_smfmac_f32_16x16x64_bf16 v[16:19], v[36:39], v[128:135], v3
    s_branch L_pvdoneB
L_longB:
    s_waitcnt lgkmcnt(4)
    v_smfmac_f32_16x16x64_bf16 v[16:19], v[20:23], v[160:167], v3
    ds_read_b128 v[20:23], v7 offset:128
    s_waitcnt lgkmcnt(4)
    v_smfmac_f32_16x16x64_bf16 v[16:19], v[24:27], v[152:159], v3
    ds_read_b128 v[24:27], v7 offset:256
    s_waitcnt lgkmcnt(4)
    v_smfmac_f32_16x16x64_bf16 v[16:19], v[28:31], v[144:151], v3
    ds_read_b128 v[28:31], v7 offset:0
    s_waitcnt lgkmcnt(4)
    v_smfmac_f32_16x16x64_bf16 v[16:19], v[32:35], v[136:143], v3
    s_waitcnt lgkmcnt(3)
    v_smfmac_f32_16x16x64_bf16 v[16:19], v[36:39], v[128:135], v3
    s_waitcnt lgkmcnt(2)
    v_smfmac_f32_16x16x64_bf16 v[16:19], v[20:23], v[120:127], v3
    s_cmp_eq_u32 s35, 6
    s_cbranch_scc1 L_pvdoneB
    s_waitcnt lgkmcnt(1)
    v_smfmac_f32_16x16x64_bf16 v[16:19], v[24:27], v[112:119], v3
    s_cmp_eq_u32 s35, 7
    s_cbranch_scc1 L_pvdoneB
    s_waitcnt lgkmcnt(0)
    v_smfmac_f32_16x16x64_bf16 v[16:19], v[28:31], v[104:111], v3
    s_branch L_pvdoneB
L_fewB:
    s_cmp_eq_u32 s35, 0
    s_cbranch_scc1 L_pvdoneB
    s_cmp_eq_u32 s35, 1
    s_waitcnt lgkmcnt(0)
    v_smfmac_f32_16x16x64_bf16 v[16:19], v[20:23], v[160:167], v3
    s_cbranch_scc1 L_pvdoneB
    v_smfmac_f32_16x16x64_bf16 v[16:19], v[24:27], v[152:159], v3
    s_branch L_pvdoneB
L_g_c3:
    s_mov_b64 exec, vcc
    v_lshlrev_b32_sdwa v67, 2, v43 dst_sel:DWORD dst_unused:UNUSED_PAD src0_sel:DWORD src1_sel:WORD_1
    ds_add_rtn_u32 v75, v67, v90 offset:46976
    v_mul_u32_u24 v67, 68, v67
    v_lshlrev_b32_sdwa v43, 9, v43 dst_sel:DWORD dst_unused:UNUSED_PAD src0_sel:DWORD src1_sel:WORD_0
    s_waitcnt lgkmcnt(0)
    v_and_b32 v75, v91, v75
    v_add_u32 v67, v67, v75
    ds_write_b32 v67, v43 offset:20480
    s_and_b32 exec_lo, exec_lo, 0x80808080
    s_and_b32 exec_hi, exec_hi, 0x80808080
    ds_or_b32 v93, v92 offset:47244
    s_branch L_g_c012
L_g_timeout:
    s_waitcnt vmcnt(0)
    s_mov_b64 exec, 1
    ds_or_b32 v93, v87 offset:47244
    s_branch L_g_cdone
L_g_epmax:
    buffer_atomic_umax v2, v1, s[20:23], s6 offen sc1
    s_branch L_g_noep
L_g_allslow:
    v_mov_b32 v5, 64
    s_branch L_g_first
L_fixF:
    s_sub_u32 s36, s34, 8
    s_cmp_gt_u32 s34, 16
    s_cselect_b32 s36, -1, s36
    s_cselect_b32 s34, 0, 8
    s_cbranch_scc1 L_issuedF
    s_branch L_issF_0
L_fixA:
    s_sub_u32 s37, s35, 8
    s_cmp_gt_u32 s35, 16
    s_cselect_b32 s37, -1, s37
    s_cselect_b32 s35, 0, 8
    s_cbranch_scc1 L_issuedA
    s_branch L_issA_0
L_fixB:
    s_sub_u32 s36, s34, 8
    s_cmp_gt_u32 s34, 16
    s_cselect_b32 s36, -1, s36
    s_cselect_b32 s34, 0, 8
    s_cbranch_scc1 L_issuedB
    s_branch L_issB_0
L_extraA:
    s_add_u32 s41, s32, s4
    s_and_b32 s42, s41, 63
    s_mulk_i32 s42, 272
    s_mov_b32 s40, 0
    s_mov_b32 s43, s36
    s_mov_b32 s36, 0
    s_cmp_eq_u32 s43, -1
    s_cbranch_scc1 L_scanA
    s_mov_b32 s40, 640000
    s_add_u32 s6, s42, 32
L_stepsA:
    v_add_u32 v112, s6, v2
L_stepA:
    ds_read_b32 v113, v112 offset:20480
    v_add_u32 v112, 4, v112
    s_waitcnt lgkmcnt(0)
    v_or_b32 v113, v113, v1
    buffer_load_dwordx4 v[104:107], v113, s[8:11], 0 offen
    buffer_load_dwordx4 v[108:111], v113, s[8:11], 0 offen offset:256
    s_waitcnt vmcnt(0)
    v_dot2_f32_bf16 v27, v104, v8, 0
    v_dot2_f32_bf16 v27, v105, v9, v27
    v_dot2_f32_bf16 v27, v106, v10, v27
    v_dot2_f32_bf16 v27, v107, v11, v27
    v_dot2_f32_bf16 v27, v108, v12, v27
    v_dot2_f32_bf16 v27, v109, v13, v27
    v_dot2_f32_bf16 v27, v110, v14, v27
    v_dot2_f32_bf16 v27, v111, v15, v27
    v_add_f32_dpp v24, v24, v24 row_ror:8 row_mask:0xf bank_mask:0xf
    v_add_f32_dpp v26, v26, v26 row_ror:8 row_mask:0xf bank_mask:0xf
    v_add_f32_dpp v24, v25, v25 row_ror:8 row_mask:0xf bank_mask:0xc
    v_add_f32_dpp v26, v27, v27 row_ror:8 row_mask:0xf bank_mask:0xc
    s_nop 0
    v_add_f32_dpp v25, v24, v24 row_half_mirror row_mask:0xf bank_mask:0xf
    v_add_f32_dpp v25, v26, v26 row_half_mirror row_mask:0xf bank_mask:0xa
    s_nop 1
    v_add_f32_dpp v25, v25, v25 quad_perm:[2,3,0,1] row_mask:0xf bank_mask:0xf
    s_nop 1
    v_add_f32_dpp v25, v25, v25 quad_perm:[1,0,3,2] row_mask:0xf bank_mask:0xf
    v_mul_f32 v25, 0xbdb8aa3b, v25
    v_exp_f32 v25, v25
    s_nop 0
    v_add_f32 v25, 1.0, v25
    v_rcp_f32 v25, v25
    s_nop 0
    v_cvt_pk_bf16_f32 v0, v25, 0
    ds_write_b32 v6, v0
    ds_read_b128 v[20:23], v7 offset:448
    s_waitcnt lgkmcnt(0)
    v_smfmac_f32_16x16x64_bf16 v[16:19], v[20:23], v[104:111], v3
    s_sub_u32 s43, s43, 1
    s_cmp_lg_u32 s43, 0
    s_cbranch_scc1 L_stepA
L_scanA:
    s_cmp_ge_u32 s40, 640000
    s_cbranch_scc1 L_phA_go
    v_mbcnt_lo_u32_b32 v112, -1, 0
    v_mbcnt_hi_u32_b32 v112, -1, v112
    v_lshlrev_b32 v112, 2, v112
    v_add_u32 v117, s40, v112
    global_load_dword v113, v117, s[14:15]
    global_load_dword v114, v117, s[12:13]
    s_add_u32 s40, s40, 256
    s_waitcnt vmcnt(0)
    v_cmp_eq_u32 vcc, s41, v113
    v_add_u32 v112, s42, v112
    v_bfrev_b32 v115, -2
    s_bcnt1_i32_b64 s43, vcc
    s_cbranch_scc0 L_scanA
    v_mbcnt_lo_u32_b32 v116, vcc_lo, 0
    v_mbcnt_hi_u32_b32 v116, vcc_hi, v116
    v_mul_u32_u24 v116, 65, v116
    v_and_b32 v116, 0xfc, v116
    v_add_u32 v116, s42, v116
    v_lshlrev_b32 v114, 9, v114
    ds_write_b32 v112, v115 offset:20480
    s_mov_b64 exec, vcc
    ds_write_b32 v116, v114 offset:20480
    s_mov_b64 exec, -1
    s_add_u32 s43, s43, 3
    s_lshr_b32 s43, s43, 2
    s_mov_b32 s6, s42
    s_branch L_stepsA
L_extraB:
    s_add_u32 s41, s33, s4
    s_and_b32 s42, s41, 63
    s_mulk_i32 s42, 272
    s_mov_b32 s40, 0
    s_mov_b32 s43, s37
    s_mov_b32 s37, 0
    s_cmp_eq_u32 s43, -1
    s_cbranch_scc1 L_scanB
    s_mov_b32 s40, 640000
    s_add_u32 s6, s42, 32
L_stepsB:
    v_add_u32 v48, s6, v2
L_stepB:
    ds_read_b32 v49, v48 offset:20480
    v_add_u32 v48, 4, v48
    s_waitcnt lgkmcnt(0)
    v_or_b32 v49, v49, v1
    buffer_load_dwordx4 v[40:43], v49, s[8:11], 0 offen
    buffer_load_dwordx4 v[44:47], v49, s[8:11], 0 offen offset:256
    s_waitcnt vmcnt(0)
    v_dot2_f32_bf16 v27, v40, v8, 0
    v_dot2_f32_bf16 v27, v41, v9, v27
    v_dot2_f32_bf16 v27, v42, v10, v27
    v_dot2_f32_bf16 v27, v43, v11, v27
    v_dot2_f32_bf16 v27, v44, v12, v27
    v_dot2_f32_bf16 v27, v45, v13, v27
    v_dot2_f32_bf16 v27, v46, v14, v27
    v_dot2_f32_bf16 v27, v47, v15, v27
    v_add_f32_dpp v24, v24, v24 row_ror:8 row_mask:0xf bank_mask:0xf
    v_add_f32_dpp v26, v26, v26 row_ror:8 row_mask:0xf bank_mask:0xf
    v_add_f32_dpp v24, v25, v25 row_ror:8 row_mask:0xf bank_mask:0xc
    v_add_f32_dpp v26, v27, v27 row_ror:8 row_mask:0xf bank_mask:0xc
    s_nop 0
    v_add_f32_dpp v25, v24, v24 row_half_mirror row_mask:0xf bank_mask:0xf
    v_add_f32_dpp v25, v26, v26 row_half_mirror row_mask:0xf bank_mask:0xa
    s_nop 1
    v_add_f32_dpp v25, v25, v25 quad_perm:[2,3,0,1] row_mask:0xf bank_mask:0xf
    s_nop 1
    v_add_f32_dpp v25, v25, v25 quad_perm:[1,0,3,2] row_mask:0xf bank_mask:0xf
    v_mul_f32 v25, 0xbdb8aa3b, v25
    v_exp_f32 v25, v25
    s_nop 0
    v_add_f32 v25, 1.0, v25
    v_rcp_f32 v25, v25
    s_nop 0
    v_cvt_pk_bf16_f32 v0, v25, 0
    ds_write_b32 v6, v0
    ds_read_b128 v[20:23], v7 offset:448
    s_waitcnt lgkmcnt(0)
    v_smfmac_f32_16x16x64_bf16 v[16:19], v[20:23], v[40:47], v3
    s_sub_u32 s43, s43, 1
    s_cmp_lg_u32 s43, 0
    s_cbranch_scc1 L_stepB
L_scanB:
    s_cmp_ge_u32 s40, 640000
    s_cbranch_scc1 L_phB_go
    v_mbcnt_lo_u32_b32 v48, -1, 0
    v_mbcnt_hi_u32_b32 v48, -1, v48
    v_lshlrev_b32 v48, 2, v48
    v_add_u32 v53, s40, v48
    global_load_dword v49, v53, s[14:15]
    global_load_dword v50, v53, s[12:13]
    s_add_u32 s40, s40, 256
    s_waitcnt vmcnt(0)
    v_cmp_eq_u32 vcc, s41, v49
    v_add_u32 v48, s42, v48
    v_bfrev_b32 v51, -2
    s_bcnt1_i32_b64 s43, vcc
    s_cbranch_scc0 L_scanB
    v_mbcnt_lo_u32_b32 v52, vcc_lo, 0
    v_mbcnt_hi_u32_b32 v52, vcc_hi, v52
    v_mul_u32_u24 v52, 65, v52
    v_and_b32 v52, 0xfc, v52
    v_add_u32 v52, s42, v52
    v_lshlrev_b32 v50, 9, v50
    ds_write_b32 v48, v51 offset:20480
    s_mov_b64 exec, vcc
    ds_write_b32 v52, v50 offset:20480
    s_mov_b64 exec, -1
    s_add_u32 s43, s43, 3
    s_lshr_b32 s43, s43, 2
    s_mov_b32 s6, s42
    s_branch L_stepsB
L_m2:
    v_and_b32 v19, 15, v0
    v_lshrrev_b32 v20, 4, v0
    v_and_b32 v22, 7, v0
    s_lshl_b32 s7, s30, 7
    v_lshl_or_b32 v6, v19, 2, s7
    v_lshl_or_b32 v0, v20, 11, v6
    s_mov_b32 s26, 5120000
    s_mov_b32 s27, 0x20000
    v_mov_b32 v1, 0x8888
    v_mov_b32 v2, 0xdddd
    v_cmp_gt_u32 vcc, 8, v19
    v_mov_b32 v12, 0
    v_mov_b32 v13, 1
    v_cndmask_b32 v14, v2, v1, vcc
    v_lshlrev_b32 v4, 1, v22
    v_and_b32 v21, 1, v20
    v_lshlrev_b32 v5, 3, v21
    v_lshrrev_b32 v21, 1, v20
    v_lshl_or_b32 v6, v21, 6, v6
    v_mul_u32_u24 v3, 544, v22
    v_lshl_add_u32 v3, v20, 4, v3
    v_add_u32 v3, 73728, v3
    s_mov_b32 s6, 53248
    v_xor_b32 v21, v19, v20
    v_lshl_add_u32 v21, v21, 4, s6
    v_lshl_add_u32 v8, v19, 9, v21
    v_xor_b32 v9, 64, v8
    v_xor_b32 v10, 128, v8
    v_xor_b32 v11, 192, v8
    s_movk_i32 s35, 0x200
    v_xor_b32 v21, v22, v20
    v_lshl_add_u32 v21, v21, 4, s6
    v_lshl_add_u32 v160, v22, 9, v21
    v_xor_b32 v161, 64, v160
    v_xor_b32 v162, 128, v160
    v_xor_b32 v163, 192, v160
    v_lshl_add_u32 v164, v5, 8, v6
    v_add_u32 v6, s31, v6
    v_mov_b64 v[120:121], 0
    v_mov_b64 v[122:123], 0
    v_mov_b64 v[124:125], 0
    v_mov_b64 v[126:127], 0
    v_mov_b64 v[128:129], 0
    v_mov_b64 v[130:131], 0
    v_mov_b64 v[132:133], 0
    v_mov_b64 v[134:135], 0
    v_mov_b64 v[136:137], 0
    v_mov_b64 v[138:139], 0
    v_mov_b64 v[140:141], 0
    v_mov_b64 v[142:143], 0
    v_mov_b64 v[144:145], 0
    v_mov_b64 v[146:147], 0
    v_mov_b64 v[148:149], 0
    v_mov_b64 v[150:151], 0
    v_mov_b64 v[152:153], 0
    v_mov_b64 v[154:155], 0
    v_mov_b64 v[156:157], 0
    v_mov_b64 v[158:159], 0
    s_mov_b64 exec, 1
    s_waitcnt vmcnt(1)
    ds_add_u32 v12, v13 offset:47236
    s_mov_b64 exec, -1
    s_add_u32 s38, s16, 0
    s_addc_u32 s39, s17, 0
    global_load_dword v72, v0, s[38:39] offset:0
    global_load_dword v80, v0, s[38:39] offset:64
    global_load_dword v73, v0, s[38:39] offset:512
    global_load_dword v81, v0, s[38:39] offset:576
    global_load_dword v74, v0, s[38:39] offset:1024
    global_load_dword v82, v0, s[38:39] offset:1088
    global_load_dword v75, v0, s[38:39] offset:1536
    global_load_dword v83, v0, s[38:39] offset:1600
    s_add_u32 s38, s16, 8192
    s_addc_u32 s39, s17, 0
    global_load_dword v76, v0, s[38:39] offset:0
    global_load_dword v84, v0, s[38:39] offset:64
    global_load_dword v77, v0, s[38:39] offset:512
    global_load_dword v85, v0, s[38:39] offset:576
    global_load_dword v78, v0, s[38:39] offset:1024
    global_load_dword v86, v0, s[38:39] offset:1088
    global_load_dword v79, v0, s[38:39] offset:1536
    global_load_dword v87, v0, s[38:39] offset:1600
    s_add_u32 s38, s16, 16384
    s_addc_u32 s39, s17, 0
    global_load_dword v88, v0, s[38:39] offset:0
    global_load_dword v96, v0, s[38:39] offset:64
    global_load_dword v89, v0, s[38:39] offset:512
    global_load_dword v97, v0, s[38:39] offset:576
    global_load_dword v90, v0, s[38:39] offset:1024
    global_load_dword v98, v0, s[38:39] offset:1088
    global_load_dword v91, v0, s[38:39] offset:1536
    global_load_dword v99, v0, s[38:39] offset:1600
    s_add_u32 s38, s16, 24576
    s_addc_u32 s39, s17, 0
    global_load_dword v92, v0, s[38:39] offset:0
    global_load_dword v100, v0, s[38:39] offset:64
    global_load_dword v93, v0, s[38:39] offset:512
    global_load_dword v101, v0, s[38:39] offset:576
    global_load_dword v94, v0, s[38:39] offset:1024
    global_load_dword v102, v0, s[38:39] offset:1088
    global_load_dword v95, v0, s[38:39] offset:1536
    global_load_dword v103, v0, s[38:39] offset:1600
    s_add_u32 s38, s16, 32768
    s_addc_u32 s39, s17, 0
    global_load_dword v104, v0, s[38:39] offset:0
    global_load_dword v112, v0, s[38:39] offset:64
    global_load_dword v105, v0, s[38:39] offset:512
    global_load_dword v113, v0, s[38:39] offset:576
    global_load_dword v106, v0, s[38:39] offset:1024
    global_load_dword v114, v0, s[38:39] offset:1088
    global_load_dword v107, v0, s[38:39] offset:1536
    global_load_dword v115, v0, s[38:39] offset:1600
    s_add_u32 s38, s16, 40960
    s_addc_u32 s39, s17, 0
    global_load_dword v108, v0, s[38:39] offset:0
    global_load_dword v116, v0, s[38:39] offset:64
    global_load_dword v109, v0, s[38:39] offset:512
    global_load_dword v117, v0, s[38:39] offset:576
    global_load_dword v110, v0, s[38:39] offset:1024
    global_load_dword v118, v0, s[38:39] offset:1088
    global_load_dword v111, v0, s[38:39] offset:1536
    global_load_dword v119, v0, s[38:39] offset:1600
    s_add_u32 s38, s16, 49152
    s_addc_u32 s39, s17, 0
    global_load_dword v40, v0, s[38:39] offset:0
    global_load_dword v48, v0, s[38:39] offset:64
    global_load_dword v41, v0, s[38:39] offset:512
    global_load_dword v49, v0, s[38:39] offset:576
    global_load_dword v42, v0, s[38:39] offset:1024
    global_load_dword v50, v0, s[38:39] offset:1088
    global_load_dword v43, v0, s[38:39] offset:1536
    global_load_dword v51, v0, s[38:39] offset:1600
    s_add_u32 s38, s16, 57344
    s_addc_u32 s39, s17, 0
    global_load_dword v44, v0, s[38:39] offset:0
    global_load_dword v52, v0, s[38:39] offset:64
    global_load_dword v45, v0, s[38:39] offset:512
    global_load_dword v53, v0, s[38:39] offset:576
    global_load_dword v46, v0, s[38:39] offset:1024
    global_load_dword v54, v0, s[38:39] offset:1088
    global_load_dword v47, v0, s[38:39] offset:1536
    global_load_dword v55, v0, s[38:39] offset:1600
L_m_xsync:
    ds_read_b32 v7, v12 offset:47236
    s_add_u32 s62, s62, 128
    s_cbranch_scc1 L_end
    s_waitcnt lgkmcnt(0)
    v_readfirstlane_b32 s6, v7
    s_cmp_lg_u32 s6, 4
    s_cbranch_scc1 L_m_xsync
    v_add_u32 v7, 64, v0
    ds_read_b128 v[16:19], v8 offset:0
    ds_read_b128 v[20:23], v8 offset:8192
    ds_read_b128 v[24:27], v160 offset:16384
    ds_read_b128 v[28:31], v9 offset:0
    ds_read_b128 v[32:35], v9 offset:8192
    ds_read_b128 v[36:39], v161 offset:16384
    s_waitcnt vmcnt(48)
    s_waitcnt lgkmcnt(3)
    v_smfmac_f32_16x16x64_bf16 v[120:123], v[16:19], v[72:79], v1
    s_add_u32 s38, s16, 65536
    s_addc_u32 s39, s17, 0
    v_smfmac_f32_16x16x64_bf16 v[124:127], v[16:19], v[72:79], v2
    global_load_dword v56, v0, s[38:39] offset:0
    global_load_dword v64, v0, s[38:39] offset:64
    v_smfmac_f32_16x16x64_bf16 v[128:131], v[16:19], v[80:87], v1
    global_load_dword v57, v0, s[38:39] offset:512
    global_load_dword v65, v0, s[38:39] offset:576
    v_smfmac_f32_16x16x64_bf16 v[132:135], v[16:19], v[80:87], v2
    global_load_dword v58, v0, s[38:39] offset:1024
    global_load_dword v66, v0, s[38:39] offset:1088
    v_smfmac_f32_16x16x64_bf16 v[136:139], v[20:23], v[72:79], v1
    global_load_dword v59, v0, s[38:39] offset:1536
    global_load_dword v67, v0, s[38:39] offset:1600
    v_smfmac_f32_16x16x64_bf16 v[140:143], v[20:23], v[72:79], v2
    s_add_u32 s38, s16, 73728
    s_addc_u32 s39, s17, 0
    v_smfmac_f32_16x16x64_bf16 v[144:147], v[20:23], v[80:87], v1
    global_load_dword v60, v0, s[38:39] offset:0
    global_load_dword v68, v0, s[38:39] offset:64
    v_smfmac_f32_16x16x64_bf16 v[148:151], v[20:23], v[80:87], v2
    global_load_dword v61, v0, s[38:39] offset:512
    global_load_dword v69, v0, s[38:39] offset:576
    v_smfmac_f32_16x16x64_bf16 v[152:155], v[24:27], v[72:79], v14
    global_load_dword v62, v0, s[38:39] offset:1024
    global_load_dword v70, v0, s[38:39] offset:1088
    v_smfmac_f32_16x16x64_bf16 v[156:159], v[24:27], v[80:87], v14
    global_load_dword v63, v0, s[38:39] offset:1536
    global_load_dword v71, v0, s[38:39] offset:1600
    ds_read_b128 v[16:19], v10 offset:0
    ds_read_b128 v[20:23], v10 offset:8192
    ds_read_b128 v[24:27], v162 offset:16384
    s_waitcnt vmcnt(48)
    s_waitcnt lgkmcnt(3)
    v_smfmac_f32_16x16x64_bf16 v[120:123], v[28:31], v[88:95], v1
    s_add_u32 s38, s16, 81920
    s_addc_u32 s39, s17, 0
    v_smfmac_f32_16x16x64_bf16 v[124:127], v[28:31], v[88:95], v2
    global_load_dword v72, v0, s[38:39] offset:0
    global_load_dword v80, v0, s[38:39] offset:64
    v_smfmac_f32_16x16x64_bf16 v[128:131], v[28:31], v[96:103], v1
    global_load_dword v73, v0, s[38:39] offset:512
    global_load_dword v81, v0, s[38:39] offset:576
    v_smfmac_f32_16x16x64_bf16 v[132:135], v[28:31], v[96:103], v2
    global_load_dword v74, v0, s[38:39] offset:1024
    global_load_dword v82, v0, s[38:39] offset:1088
    v_smfmac_f32_16x16x64_bf16 v[136:139], v[32:35], v[88:95], v1
    global_load_dword v75, v0, s[38:39] offset:1536
    global_load_dword v83, v0, s[38:39] offset:1600
    v_smfmac_f32_16x16x64_bf16 v[140:143], v[32:35], v[88:95], v2
    s_add_u32 s38, s16, 90112
    s_addc_u32 s39, s17, 0
    v_smfmac_f32_16x16x64_bf16 v[144:147], v[32:35], v[96:103], v1
    global_load_dword v76, v0, s[38:39] offset:0
    global_load_dword v84, v0, s[38:39] offset:64
    v_smfmac_f32_16x16x64_bf16 v[148:151], v[32:35], v[96:103], v2
    global_load_dword v77, v0, s[38:39] offset:512
    global_load_dword v85, v0, s[38:39] offset:576
    v_smfmac_f32_16x16x64_bf16 v[152:155], v[36:39], v[88:95], v14
    global_load_dword v78, v0, s[38:39] offset:1024
    global_load_dword v86, v0, s[38:39] offset:1088
    v_smfmac_f32_16x16x64_bf16 v[156:159], v[36:39], v[96:103], v14
    global_load_dword v79, v0, s[38:39] offset:1536
    global_load_dword v87, v0, s[38:39] offset:1600
    ds_read_b128 v[28:31], v11 offset:0
    ds_read_b128 v[32:35], v11 offset:8192
    ds_read_b128 v[36:39], v163 offset:16384
    s_waitcnt vmcnt(48)
    s_waitcnt lgkmcnt(3)
    v_smfmac_f32_16x16x64_bf16 v[120:123], v[16:19], v[104:111], v1
    s_add_u32 s38, s16, 98304
    s_addc_u32 s39, s17, 0
    v_smfmac_f32_16x16x64_bf16 v[124:127], v[16:19], v[104:111], v2
    global_load_dword v88, v0, s[38:39] offset:0
    global_load_dword v96, v0, s[38:39] offset:64
    v_smfmac_f32_16x16x64_bf16 v[128:131], v[16:19], v[112:119], v1
    global_load_dword v89, v0, s[38:39] offset:512
    global_load_dword v97, v0, s[38:39] offset:576
    v_smfmac_f32_16x16x64_bf16 v[132:135], v[16:19], v[112:119], v2
    global_load_dword v90, v0, s[38:39] offset:1024
    global_load_dword v98, v0, s[38:39] offset:1088
    v_smfmac_f32_16x16x64_bf16 v[136:139], v[20:23], v[104:111], v1
    global_load_dword v91, v0, s[38:39] offset:1536
    global_load_dword v99, v0, s[38:39] offset:1600
    v_smfmac_f32_16x16x64_bf16 v[140:143], v[20:23], v[104:111], v2
    s_add_u32 s38, s16, 106496
    s_addc_u32 s39, s17, 0
    v_smfmac_f32_16x16x64_bf16 v[144:147], v[20:23], v[112:119], v1
    global_load_dword v92, v0, s[38:39] offset:0
    global_load_dword v100, v0, s[38:39] offset:64
    v_smfmac_f32_16x16x64_bf16 v[148:151], v[20:23], v[112:119], v2
    global_load_dword v93, v0, s[38:39] offset:512
    global_load_dword v101, v0, s[38:39] offset:576
    v_smfmac_f32_16x16x64_bf16 v[152:155], v[24:27], v[104:111], v14
    global_load_dword v94, v0, s[38:39] offset:1024
    global_load_dword v102, v0, s[38:39] offset:1088
    v_smfmac_f32_16x16x64_bf16 v[156:159], v[24:27], v[112:119], v14
    global_load_dword v95, v0, s[38:39] offset:1536
    global_load_dword v103, v0, s[38:39] offset:1600
    ds_read_b128 v[16:19], v8 offset:256
    ds_read_b128 v[20:23], v8 offset:8448
    ds_read_b128 v[24:27], v160 offset:16640
    s_waitcnt vmcnt(48)
    s_waitcnt lgkmcnt(3)
    v_smfmac_f32_16x16x64_bf16 v[120:123], v[28:31], v[40:47], v1
    s_add_u32 s38, s16, 114688
    s_addc_u32 s39, s17, 0
    v_smfmac_f32_16x16x64_bf16 v[124:127], v[28:31], v[40:47], v2
    global_load_dword v104, v0, s[38:39] offset:0
    global_load_dword v112, v0, s[38:39] offset:64
    v_smfmac_f32_16x16x64_bf16 v[128:131], v[28:31], v[48:55], v1
    global_load_dword v105, v0, s[38:39] offset:512
    global_load_dword v113, v0, s[38:39] offset:576
    v_smfmac_f32_16x16x64_bf16 v[132:135], v[28:31], v[48:55], v2
    global_load_dword v106, v0, s[38:39] offset:1024
    global_load_dword v114, v0, s[38:39] offset:1088
    v_smfmac_f32_16x16x64_bf16 v[136:139], v[32:35], v[40:47], v1
    global_load_dword v107, v0, s[38:39] offset:1536
    global_load_dword v115, v0, s[38:39] offset:1600
    v_smfmac_f32_16x16x64_bf16 v[140:143], v[32:35], v[40:47], v2
    s_add_u32 s38, s16, 122880
    s_addc_u32 s39, s17, 0
    v_smfmac_f32_16x16x64_bf16 v[144:147], v[32:35], v[48:55], v1
    global_load_dword v108, v0, s[38:39] offset:0
    global_load_dword v116, v0, s[38:39] offset:64
    v_smfmac_f32_16x16x64_bf16 v[148:151], v[32:35], v[48:55], v2
    global_load_dword v109, v0, s[38:39] offset:512
    global_load_dword v117, v0, s[38:39] offset:576
    v_smfmac_f32_16x16x64_bf16 v[152:155], v[36:39], v[40:47], v14
    global_load_dword v110, v0, s[38:39] offset:1024
    global_load_dword v118, v0, s[38:39] offset:1088
    v_smfmac_f32_16x16x64_bf16 v[156:159], v[36:39], v[48:55], v14
    global_load_dword v111, v0, s[38:39] offset:1536
    global_load_dword v119, v0, s[38:39] offset:1600
    ds_read_b128 v[28:31], v9 offset:256
    ds_read_b128 v[32:35], v9 offset:8448
    ds_read_b128 v[36:39], v161 offset:16640
    s_waitcnt vmcnt(48)
    s_waitcnt lgkmcnt(3)
    v_smfmac_f32_16x16x64_bf16 v[120:123], v[16:19], v[56:63], v1
    s_add_u32 s38, s18, 0
    s_addc_u32 s39, s19, 0
    v_smfmac_f32_16x16x64_bf16 v[124:127], v[16:19], v[56:63], v2
    global_load_dword v40, v0, s[38:39] offset:0
    global_load_dword v48, v0, s[38:39] offset:64
    v_smfmac_f32_16x16x64_bf16 v[128:131], v[16:19], v[64:71], v1
    global_load_dword v41, v0, s[38:39] offset:512
    global_load_dword v49, v0, s[38:39] offset:576
    v_smfmac_f32_16x16x64_bf16 v[132:135], v[16:19], v[64:71], v2
    global_load_dword v42, v0, s[38:39] offset:1024
    global_load_dword v50, v0, s[38:39] offset:1088
    v_smfmac_f32_16x16x64_bf16 v[136:139], v[20:23], v[56:63], v1
    global_load_dword v43, v0, s[38:39] offset:1536
    global_load_dword v51, v0, s[38:39] offset:1600
    v_smfmac_f32_16x16x64_bf16 v[140:143], v[20:23], v[56:63], v2
    s_add_u32 s38, s18, 8192
    s_addc_u32 s39, s19, 0
    v_smfmac_f32_16x16x64_bf16 v[144:147], v[20:23], v[64:71], v1
    global_load_dword v44, v0, s[38:39] offset:0
    global_load_dword v52, v0, s[38:39] offset:64
    v_smfmac_f32_16x16x64_bf16 v[148:151], v[20:23], v[64:71], v2
    global_load_dword v45, v0, s[38:39] offset:512
    global_load_dword v53, v0, s[38:39] offset:576
    v_smfmac_f32_16x16x64_bf16 v[152:155], v[24:27], v[56:63], v14
    global_load_dword v46, v0, s[38:39] offset:1024
    global_load_dword v54, v0, s[38:39] offset:1088
    v_smfmac_f32_16x16x64_bf16 v[156:159], v[24:27], v[64:71], v14
    global_load_dword v47, v0, s[38:39] offset:1536
    global_load_dword v55, v0, s[38:39] offset:1600
    ds_read_b128 v[16:19], v10 offset:256
    ds_read_b128 v[20:23], v10 offset:8448
    ds_read_b128 v[24:27], v162 offset:16640
    s_waitcnt vmcnt(48)
    s_waitcnt lgkmcnt(3)
    v_smfmac_f32_16x16x64_bf16 v[120:123], v[28:31], v[72:79], v1
    s_add_u32 s38, s18, 16384
    s_addc_u32 s39, s19, 0
    v_smfmac_f32_16x16x64_bf16 v[124:127], v[28:31], v[72:79], v2
    global_load_dword v56, v0, s[38:39] offset:0
    global_load_dword v64, v0, s[38:39] offset:64
    v_smfmac_f32_16x16x64_bf16 v[128:131], v[28:31], v[80:87], v1
    global_load_dword v57, v0, s[38:39] offset:512
    global_load_dword v65, v0, s[38:39] offset:576
    v_smfmac_f32_16x16x64_bf16 v[132:135], v[28:31], v[80:87], v2
    global_load_dword v58, v0, s[38:39] offset:1024
    global_load_dword v66, v0, s[38:39] offset:1088
    v_smfmac_f32_16x16x64_bf16 v[136:139], v[32:35], v[72:79], v1
    global_load_dword v59, v0, s[38:39] offset:1536
    global_load_dword v67, v0, s[38:39] offset:1600
    v_smfmac_f32_16x16x64_bf16 v[140:143], v[32:35], v[72:79], v2
    s_add_u32 s38, s18, 24576
    s_addc_u32 s39, s19, 0
    v_smfmac_f32_16x16x64_bf16 v[144:147], v[32:35], v[80:87], v1
    global_load_dword v60, v0, s[38:39] offset:0
    global_load_dword v68, v0, s[38:39] offset:64
    v_smfmac_f32_16x16x64_bf16 v[148:151], v[32:35], v[80:87], v2
    global_load_dword v61, v0, s[38:39] offset:512
    global_load_dword v69, v0, s[38:39] offset:576
    v_smfmac_f32_16x16x64_bf16 v[152:155], v[36:39], v[72:79], v14
    global_load_dword v62, v0, s[38:39] offset:1024
    global_load_dword v70, v0, s[38:39] offset:1088
    v_smfmac_f32_16x16x64_bf16 v[156:159], v[36:39], v[80:87], v14
    global_load_dword v63, v0, s[38:39] offset:1536
    global_load_dword v71, v0, s[38:39] offset:1600
    ds_read_b128 v[28:31], v11 offset:256
    ds_read_b128 v[32:35], v11 offset:8448
    ds_read_b128 v[36:39], v163 offset:16640
    s_waitcnt vmcnt(48)
    s_waitcnt lgkmcnt(3)
    v_smfmac_f32_16x16x64_bf16 v[120:123], v[16:19], v[88:95], v1
    s_add_u32 s38, s18, 32768
    s_addc_u32 s39, s19, 0
    v_smfmac_f32_16x16x64_bf16 v[124:127], v[16:19], v[88:95], v2
    global_load_dword v72, v0, s[38:39] offset:0
    global_load_dword v80, v0, s[38:39] offset:64
    v_smfmac_f32_16x16x64_bf16 v[128:131], v[16:19], v[96:103], v1
    global_load_dword v73, v0, s[38:39] offset:512
    global_load_dword v81, v0, s[38:39] offset:576
    v_smfmac_f32_16x16x64_bf16 v[132:135], v[16:19], v[96:103], v2
    global_load_dword v74, v0, s[38:39] offset:1024
    global_load_dword v82, v0, s[38:39] offset:1088
    v_smfmac_f32_16x16x64_bf16 v[136:139], v[20:23], v[88:95], v1
    global_load_dword v75, v0, s[38:39] offset:1536
    global_load_dword v83, v0, s[38:39] offset:1600
    v_smfmac_f32_16x16x64_bf16 v[140:143], v[20:23], v[88:95], v2
    s_add_u32 s38, s18, 40960
    s_addc_u32 s39, s19, 0
    v_smfmac_f32_16x16x64_bf16 v[144:147], v[20:23], v[96:103], v1
    global_load_dword v76, v0, s[38:39] offset:0
    global_load_dword v84, v0, s[38:39] offset:64
    v_smfmac_f32_16x16x64_bf16 v[148:151], v[20:23], v[96:103], v2
    global_load_dword v77, v0, s[38:39] offset:512
    global_load_dword v85, v0, s[38:39] offset:576
    v_smfmac_f32_16x16x64_bf16 v[152:155], v[24:27], v[88:95], v14
    global_load_dword v78, v0, s[38:39] offset:1024
    global_load_dword v86, v0, s[38:39] offset:1088
    v_smfmac_f32_16x16x64_bf16 v[156:159], v[24:27], v[96:103], v14
    global_load_dword v79, v0, s[38:39] offset:1536
    global_load_dword v87, v0, s[38:39] offset:1600
    s_waitcnt vmcnt(48)
    s_waitcnt lgkmcnt(0)
    v_smfmac_f32_16x16x64_bf16 v[120:123], v[28:31], v[104:111], v1
    v_smfmac_f32_16x16x64_bf16 v[124:127], v[28:31], v[104:111], v2
    v_smfmac_f32_16x16x64_bf16 v[128:131], v[28:31], v[112:119], v1
    v_smfmac_f32_16x16x64_bf16 v[132:135], v[28:31], v[112:119], v2
    v_smfmac_f32_16x16x64_bf16 v[136:139], v[32:35], v[104:111], v1
    v_smfmac_f32_16x16x64_bf16 v[140:143], v[32:35], v[104:111], v2
    v_smfmac_f32_16x16x64_bf16 v[144:147], v[32:35], v[112:119], v1
    v_smfmac_f32_16x16x64_bf16 v[148:151], v[32:35], v[112:119], v2
    v_smfmac_f32_16x16x64_bf16 v[152:155], v[36:39], v[104:111], v14
    v_smfmac_f32_16x16x64_bf16 v[156:159], v[36:39], v[112:119], v14
    v_cvt_pk_bf16_f32 v120, v120, v124
    v_cvt_pk_bf16_f32 v121, v121, v125
    v_cvt_pk_bf16_f32 v122, v122, v126
    v_cvt_pk_bf16_f32 v123, v123, v127
    ds_write2st64_b32 v0, v120, v121 offset0:0 offset1:2
    ds_write2st64_b32 v0, v122, v123 offset0:4 offset1:6
    v_cvt_pk_bf16_f32 v128, v128, v132
    v_cvt_pk_bf16_f32 v129, v129, v133
    v_cvt_pk_bf16_f32 v130, v130, v134
    v_cvt_pk_bf16_f32 v131, v131, v135
    ds_write2st64_b32 v7, v128, v129 offset0:0 offset1:2
    ds_write2st64_b32 v7, v130, v131 offset0:4 offset1:6
    v_cvt_pk_bf16_f32 v136, v136, v140
    v_cvt_pk_bf16_f32 v137, v137, v141
    v_cvt_pk_bf16_f32 v138, v138, v142
    v_cvt_pk_bf16_f32 v139, v139, v143
    ds_write2st64_b32 v0, v136, v137 offset0:32 offset1:34
    ds_write2st64_b32 v0, v138, v139 offset0:36 offset1:38
    v_cvt_pk_bf16_f32 v144, v144, v148
    v_cvt_pk_bf16_f32 v145, v145, v149
    v_cvt_pk_bf16_f32 v146, v146, v150
    v_cvt_pk_bf16_f32 v147, v147, v151
    ds_write2st64_b32 v7, v144, v145 offset0:32 offset1:34
    ds_write2st64_b32 v7, v146, v147 offset0:36 offset1:38
    v_permlane32_swap_b32 v152, v156
    v_permlane32_swap_b32 v153, v157
    v_permlane32_swap_b32 v154, v158
    v_permlane32_swap_b32 v155, v159
    v_cvt_pk_bf16_f32 v152, v152, v156
    v_cvt_pk_bf16_f32 v153, v153, v157
    v_cvt_pk_bf16_f32 v154, v154, v158
    v_cvt_pk_bf16_f32 v155, v155, v159
    ds_write2st64_b32 v164, v152, v153 offset0:64 offset1:66
    ds_write2st64_b32 v164, v154, v155 offset0:68 offset1:70
    s_mov_b64 exec, 1
    ds_add_u32 v12, v13 offset:47248
    s_mov_b64 exec, -1
    s_setprio 2
    v_mov_b32 v1, v14
    s_waitcnt vmcnt(16)
    s_add_u32 s38, s18, 49152
    s_addc_u32 s39, s19, 0
    global_load_dword v88, v0, s[38:39] offset:0
    global_load_dword v96, v0, s[38:39] offset:64
    global_load_dword v89, v0, s[38:39] offset:512
    global_load_dword v97, v0, s[38:39] offset:576
    global_load_dword v90, v0, s[38:39] offset:1024
    global_load_dword v98, v0, s[38:39] offset:1088
    global_load_dword v91, v0, s[38:39] offset:1536
    global_load_dword v99, v0, s[38:39] offset:1600
    s_add_u32 s38, s18, 57344
    s_addc_u32 s39, s19, 0
    global_load_dword v92, v0, s[38:39] offset:0
    global_load_dword v100, v0, s[38:39] offset:64
    global_load_dword v93, v0, s[38:39] offset:512
    global_load_dword v101, v0, s[38:39] offset:576
    global_load_dword v94, v0, s[38:39] offset:1024
    global_load_dword v102, v0, s[38:39] offset:1088
    global_load_dword v95, v0, s[38:39] offset:1536
    global_load_dword v103, v0, s[38:39] offset:1600
    s_waitcnt vmcnt(16)
    s_add_u32 s38, s18, 65536
    s_addc_u32 s39, s19, 0
    global_load_dword v104, v0, s[38:39] offset:0
    global_load_dword v112, v0, s[38:39] offset:64
    global_load_dword v105, v0, s[38:39] offset:512
    global_load_dword v113, v0, s[38:39] offset:576
    global_load_dword v106, v0, s[38:39] offset:1024
    global_load_dword v114, v0, s[38:39] offset:1088
    global_load_dword v107, v0, s[38:39] offset:1536
    global_load_dword v115, v0, s[38:39] offset:1600
    s_add_u32 s38, s18, 73728
    s_addc_u32 s39, s19, 0
    global_load_dword v108, v0, s[38:39] offset:0
    global_load_dword v116, v0, s[38:39] offset:64
    global_load_dword v109, v0, s[38:39] offset:512
    global_load_dword v117, v0, s[38:39] offset:576
    global_load_dword v110, v0, s[38:39] offset:1024
    global_load_dword v118, v0, s[38:39] offset:1088
    global_load_dword v111, v0, s[38:39] offset:1536
    global_load_dword v119, v0, s[38:39] offset:1600
    s_waitcnt vmcnt(16)
    s_add_u32 s38, s18, 81920
    s_addc_u32 s39, s19, 0
    global_load_dword v120, v0, s[38:39] offset:0
    global_load_dword v128, v0, s[38:39] offset:64
    global_load_dword v121, v0, s[38:39] offset:512
    global_load_dword v129, v0, s[38:39] offset:576
    global_load_dword v122, v0, s[38:39] offset:1024
    global_load_dword v130, v0, s[38:39] offset:1088
    global_load_dword v123, v0, s[38:39] offset:1536
    global_load_dword v131, v0, s[38:39] offset:1600
    s_add_u32 s38, s18, 90112
    s_addc_u32 s39, s19, 0
    global_load_dword v124, v0, s[38:39] offset:0
    global_load_dword v132, v0, s[38:39] offset:64
    global_load_dword v125, v0, s[38:39] offset:512
    global_load_dword v133, v0, s[38:39] offset:576
    global_load_dword v126, v0, s[38:39] offset:1024
    global_load_dword v134, v0, s[38:39] offset:1088
    global_load_dword v127, v0, s[38:39] offset:1536
    global_load_dword v135, v0, s[38:39] offset:1600
    s_waitcnt vmcnt(16)
    s_add_u32 s38, s18, 98304
    s_addc_u32 s39, s19, 0
    global_load_dword v136, v0, s[38:39] offset:0
    global_load_dword v144, v0, s[38:39] offset:64
    global_load_dword v137, v0, s[38:39] offset:512
    global_load_dword v145, v0, s[38:39] offset:576
    global_load_dword v138, v0, s[38:39] offset:1024
    global_load_dword v146, v0, s[38:39] offset:1088
    global_load_dword v139, v0, s[38:39] offset:1536
    global_load_dword v147, v0, s[38:39] offset:1600
    s_add_u32 s38, s18, 106496
    s_addc_u32 s39, s19, 0
    global_load_dword v140, v0, s[38:39] offset:0
    global_load_dword v148, v0, s[38:39] offset:64
    global_load_dword v141, v0, s[38:39] offset:512
    global_load_dword v149, v0, s[38:39] offset:576
    global_load_dword v142, v0, s[38:39] offset:1024
    global_load_dword v150, v0, s[38:39] offset:1088
    global_load_dword v143, v0, s[38:39] offset:1536
    global_load_dword v151, v0, s[38:39] offset:1600
    s_waitcnt vmcnt(16)
    s_add_u32 s38, s18, 114688
    s_addc_u32 s39, s19, 0
    global_load_dword v152, v0, s[38:39] offset:0
    global_load_dword v160, v0, s[38:39] offset:64
    global_load_dword v153, v0, s[38:39] offset:512
    global_load_dword v161, v0, s[38:39] offset:576
    global_load_dword v154, v0, s[38:39] offset:1024
    global_load_dword v162, v0, s[38:39] offset:1088
    global_load_dword v155, v0, s[38:39] offset:1536
    global_load_dword v163, v0, s[38:39] offset:1600
    s_add_u32 s38, s18, 122880
    s_addc_u32 s39, s19, 0
    global_load_dword v156, v0, s[38:39] offset:0
    global_load_dword v164, v0, s[38:39] offset:64
    global_load_dword v157, v0, s[38:39] offset:512
    global_load_dword v165, v0, s[38:39] offset:576
    global_load_dword v158, v0, s[38:39] offset:1024
    global_load_dword v166, v0, s[38:39] offset:1088
    global_load_dword v159, v0, s[38:39] offset:1536
    global_load_dword v167, v0, s[38:39] offset:1600
    s_mul_i32 s33, s30, 3072
    s_add_u32 s33, s33, 53248
    v_and_b32 v0, 0x7f, v6
    v_lshl_add_u32 v0, v5, 6, v0
    v_add_u32 v0, s33, v0
    v_mbcnt_lo_u32_b32 v2, -1, 0
    v_mbcnt_hi_u32_b32 v2, -1, v2
    s_lshl_b32 s34, s30, 7
    s_add_u32 s34, s34, s31
    s_lshl_b32 s32, s5, 1
    s_mov_b32 s7, 0xffff
    s_mov_b32 s40, 5
    s_waitcnt vmcnt(0)
    s_setprio 0
L_tile:
    v_cmp_gt_i32 s[36:37], s32, v4
    v_mov_b64 v[8:9], 0
    v_mov_b64 v[10:11], 0
    v_mov_b64 v[12:13], 0
    v_mov_b64 v[14:15], 0
L_tile_wait:
    ds_read_u16 v7, v4 offset:46592
    s_add_u32 s62, s62, 128
    s_cbranch_scc1 L_end
    s_waitcnt lgkmcnt(0)
    v_cmp_eq_u32 vcc, s7, v7
    s_and_b64 vcc, vcc, s[36:37]
    s_cbranch_scc1 L_tile_wait
    ds_read_b128 v[16:19], v3 offset:0
    ds_read_b128 v[20:23], v3 offset:64
L_tile_go:
    ds_read_b128 v[24:27], v3 offset:128
    ds_read_b128 v[28:31], v3 offset:192
    ds_read_b128 v[32:35], v3 offset:256
    ds_read_b128 v[36:39], v3 offset:320
    s_waitcnt lgkmcnt(5)
    v_smfmac_f32_16x16x64_bf16 v[8:11], v[16:19], v[40:47], v1
    v_smfmac_f32_16x16x64_bf16 v[12:15], v[16:19], v[48:55], v1
    ds_read_b128 v[16:19], v3 offset:384
    s_waitcnt lgkmcnt(5)
    v_smfmac_f32_16x16x64_bf16 v[8:11], v[20:23], v[56:63], v1
    v_smfmac_f32_16x16x64_bf16 v[12:15], v[20:23], v[64:71], v1
    ds_read_b128 v[20:23], v3 offset:448
    s_waitcnt lgkmcnt(5)
    v_smfmac_f32_16x16x64_bf16 v[8:11], v[24:27], v[72:79], v1
    v_smfmac_f32_16x16x64_bf16 v[12:15], v[24:27], v[80:87], v1
    ds_read_b64 v[24:25], v5 offset:46592
    s_waitcnt lgkmcnt(5)
    v_smfmac_f32_16x16x64_bf16 v[8:11], v[28:31], v[88:95], v1
    v_smfmac_f32_16x16x64_bf16 v[12:15], v[28:31], v[96:103], v1
    s_waitcnt lgkmcnt(4)
    v_smfmac_f32_16x16x64_bf16 v[8:11], v[32:35], v[104:111], v1
    v_smfmac_f32_16x16x64_bf16 v[12:15], v[32:35], v[112:119], v1
    s_waitcnt lgkmcnt(3)
    v_smfmac_f32_16x16x64_bf16 v[8:11], v[36:39], v[120:127], v1
    v_smfmac_f32_16x16x64_bf16 v[12:15], v[36:39], v[128:135], v1
    s_waitcnt lgkmcnt(2)
    v_smfmac_f32_16x16x64_bf16 v[8:11], v[16:19], v[136:143], v1
    v_smfmac_f32_16x16x64_bf16 v[12:15], v[16:19], v[144:151], v1
    s_waitcnt lgkmcnt(1)
    v_smfmac_f32_16x16x64_bf16 v[8:11], v[20:23], v[152:159], v1
    v_smfmac_f32_16x16x64_bf16 v[12:15], v[20:23], v[160:167], v1
    s_cmp_gt_u32 s40, 2
    s_cbranch_scc1 L_park
    s_waitcnt lgkmcnt(0)
    v_mad_u32_u16 v28, v24, s35, v6 op_sel:[0,0,0,0]
    v_mad_u32_u16 v29, v24, s35, v6 op_sel:[1,0,0,0]
    v_mad_u32_u16 v30, v25, s35, v6 op_sel:[0,0,0,0]
    v_mad_u32_u16 v31, v25, s35, v6 op_sel:[1,0,0,0]
    v_add_u32 v4, 16, v4
    v_add_u32 v5, 16, v5
    v_add_u32 v3, 4352, v3
    v_permlane32_swap_b32 v8, v12
    v_cvt_pk_bf16_f32 v32, v8, v12
    buffer_store_dword v32, v28, s[24:27], 0 offen sc0 sc1
    v_permlane32_swap_b32 v9, v13
    v_cvt_pk_bf16_f32 v33, v9, v13
    buffer_store_dword v33, v29, s[24:27], 0 offen sc0 sc1
    v_permlane32_swap_b32 v10, v14
    v_cvt_pk_bf16_f32 v34, v10, v14
    buffer_store_dword v34, v30, s[24:27], 0 offen sc0 sc1
    v_permlane32_swap_b32 v11, v15
    v_cvt_pk_bf16_f32 v35, v11, v15
    buffer_store_dword v35, v31, s[24:27], 0 offen sc0 sc1
    s_cmp_lg_u32 s40, 2
    s_cbranch_scc1 L_next
    v_lshrrev_b32 v16, 3, v2
    v_lshlrev_b32 v16, 1, v16
    v_lshl_add_u32 v17, v2, 4, s33
    v_and_b32 v18, 7, v2
    v_lshl_add_u32 v18, v18, 4, s34
    ds_read_u16 v20, v16 offset:46592
    ds_read_b128 v[24:27], v17 offset:0
    ds_read_u16 v21, v16 offset:46608
    ds_read_b128 v[28:31], v17 offset:1024
    ds_read_u16 v22, v16 offset:46624
    ds_read_b128 v[32:35], v17 offset:2048
    s_waitcnt lgkmcnt(4)
    v_lshl_add_u32 v20, v20, 9, v18
    buffer_store_dwordx4 v[24:27], v20, s[24:27], 0 offen sc0 sc1
    s_waitcnt lgkmcnt(2)
    v_lshl_add_u32 v21, v21, 9, v18
    buffer_store_dwordx4 v[28:31], v21, s[24:27], 0 offen sc0 sc1
    s_waitcnt lgkmcnt(0)
    v_lshl_add_u32 v22, v22, 9, v18
    buffer_store_dwordx4 v[32:35], v22, s[24:27], 0 offen sc0 sc1
L_next:
    s_sub_u32 s40, s40, 1
    s_cmp_lg_u32 s40, 0
    s_cbranch_scc1 L_tile
    s_branch L_m_done
L_park:
    v_add_u32 v4, 16, v4
    v_add_u32 v5, 16, v5
    v_add_u32 v3, 4352, v3
    s_nop 2
    v_permlane32_swap_b32 v8, v12
    v_cvt_pk_bf16_f32 v32, v8, v12
    v_permlane32_swap_b32 v9, v13
    v_cvt_pk_bf16_f32 v33, v9, v13
    v_permlane32_swap_b32 v10, v14
    v_cvt_pk_bf16_f32 v34, v10, v14
    v_permlane32_swap_b32 v11, v15
    v_cvt_pk_bf16_f32 v35, v11, v15
    ds_write2_b32 v0, v32, v33 offset1:32
    ds_write2_b32 v0, v34, v35 offset0:64 offset1:96
    v_add_u32 v0, 1024, v0
    s_branch L_next
L_m_done:
L_end:
    s_endpgm
.section .rodata,"a"
.p2align 6
.amdhsa_kernel standalone__kernel_systems_refs_featgraph__graph_kernel
  .amdhsa_next_free_vgpr 168
  .amdhsa_next_free_sgpr 64
  .amdhsa_accum_offset 168
  .amdhsa_group_segment_fixed_size 0
  .amdhsa_kernarg_size 64
  .amdhsa_user_sgpr_count 2
  .amdhsa_user_sgpr_kernarg_segment_ptr 1
  .amdhsa_system_sgpr_workgroup_id_x 1
  .amdhsa_float_denorm_mode_32 3
.end_amdhsa_kernel
```
